```python
import torch

def _softmax(x, axis=-1):
    return torch.softmax(x, dim=axis)
def _gelu(x):
    return torch.nn.functional.gelu(x, approximate="tanh")
def _silu(x):
    return torch.nn.functional.silu(x)
def _sigmoid(x):
    return torch.sigmoid(x)
def _layernorm(x, axis=-1, eps=1e-5):
    m = x.mean(dim=axis, keepdim=True)
    v = x.var(dim=axis, keepdim=True, unbiased=False)
    return (x - m) / torch.sqrt(v + eps)
def _scatter_add(tgt, idx, src, axis=0):
    return tgt.clone().index_add_(axis, idx, src)
def _segment_sum(src, seg, n):
    out = torch.zeros((n,) + src.shape[1:], dtype=src.dtype)
    return out.index_add_(0, seg, src)
def _pad(x, pw):
    flat = tuple(v for pair in reversed(pw) for v in pair)
    return torch.nn.functional.pad(x, flat)

kernel_name = 'standalone__hybrid_graph_tf_graphgps__graph'

def setup_inputs():

    _w = (lambda a: (lambda t: t.to(torch.bfloat16) if t.is_floating_point() else t)(torch.as_tensor(a)))
    N, deg, D = 10000, 32, 128
    E = N * deg
    src = (lambda lo, hi, *s: torch.randint(lo, hi, s))(0, N, E).to(torch.int64)
    dst = (lambda lo, hi, *s: torch.randint(lo, hi, s))(0, N, E).to(torch.int64)
    deg_cnt = torch.bincount(dst, minlength=N).to(float) + 1.0
    sc = 1.0 / float(D) ** 0.5
    return {
        "x": _w((lambda *s: torch.randn(*s, dtype=torch.bfloat16) * 0.05)(N, D)),
        "src": _w(src),
        "dst": _w(dst),
        "deg_inv": _w((1.0 / deg_cnt).to(float)),
        "w_msg": _w((lambda *s: torch.randn(*s, dtype=torch.bfloat16) * 0.2)(D, D) * sc),
        "wq": _w((lambda *s: torch.randn(*s, dtype=torch.bfloat16) * 1.6)(D, D) * sc),
        "wk": _w((lambda *s: torch.randn(*s, dtype=torch.bfloat16) * 1.6)(D, D) * sc),
        "wv": _w((lambda *s: torch.randn(*s, dtype=torch.bfloat16) * 0.2)(D, D) * sc),
        "w_out": _w((lambda *s: torch.randn(*s, dtype=torch.bfloat16) * 0.2)(D, D) * sc),
    }

def reference(x, src, dst, deg_inv, w_msg, wq, wk, wv, w_out):
    N, D = x.shape[0], x.shape[1]
    h = _layernorm(x, axis=-1)
    m_e = torch.einsum('nd,de->ne', h, w_msg)
    h_local = _segment_sum(m_e[src], dst, N) * deg_inv[:, None]
    q = torch.einsum('nd,de->ne', h, wq)
    k = torch.einsum('nd,de->ne', h, wk)
    v = torch.einsum('nd,de->ne', h, wv)
    logits = torch.einsum('id,jd->ij', q, k) / (float(D) ** 0.5)
    attn = _softmax(logits, axis=-1)
    h_global = torch.einsum('ij,jd->id', attn, v)
    y = torch.einsum('nd,de->ne', h_local + h_global, w_out)
    return x + y
```

```asm
; @launch kernel=k1_proj_kernel grid=(225,1,1) block=(256,1,1) lds=98304
; @launch kernel=k2_attn_kernel grid=(240,1,1) block=(256,1,1) lds=152832
.amdgcn_target "amdgcn-amd-amdhsa--gfx950"
.text
.globl k1_proj_kernel
.p2align 8
.type k1_proj_kernel,@function
k1_proj_kernel:
    s_cmp_ge_u32 s2, 225
    s_cbranch_scc1 L_k1_exit
    s_getpc_b64 s[36:37]
L_k1_pc2:
    s_sub_u32 s36, s36, L_k1_pc2 - k1_proj_kernel
    s_subb_u32 s37, s37, 0
    s_lshr_b32 s34, s2, 3
    s_and_b32 s34, s34, 15
    s_lshl_b32 s34, s34, 10
    v_lshl_add_u32 v236, v0, 2, s34
    global_load_dword v237, v236, s[36:37]
    s_cmp_lt_u32 s2, 64
    s_cbranch_scc1 L_k1_bucket
    s_setprio 3
    s_sub_u32 s25, s2, 64
    s_mul_i32 s23, s25, 820
    s_lshr_b32 s23, s23, 16
    s_mul_i32 s3, s23, 80
    s_sub_u32 s3, s25, s3
    s_xor_b32 s20, s23, 1
    s_min_u32 s20, s20, 2
    s_mov_b32 s23, 40
    s_cmp_eq_u32 s20, 1
    s_cselect_b32 s23, 56, s23
    s_cmp_eq_u32 s20, 2
    s_cselect_b32 s23, 64, s23
    s_cselect_b32 s35, 32, 0
    s_mov_b32 s6, 2560000
    s_cselect_b32 s6, 32768, s6
    s_cmp_eq_u32 s20, 0
    s_cselect_b32 s24, 48, 64
    s_load_dwordx2 s[4:5], s[0:1], s35
    s_load_dwordx2 s[8:9], s[0:1], s23
    s_load_dwordx2 s[12:13], s[0:1], s24
    s_load_dwordx2 s[16:17], s[0:1], 88
    v_lshrrev_b32 v1, 6, v0
    v_and_b32 v2, 63, v0
    v_readfirstlane_b32 s22, v1
    s_mov_b32 s7, 0x00020000
    s_mov_b32 s10, 32768
    s_mov_b32 s11, 0x00020000
    s_mov_b32 s14, 32768
    s_mov_b32 s15, 0x00020000
    s_mov_b32 s18, 0x10000000
    s_mov_b32 s19, 0x00020000
    s_lshl_b32 s21, s3, 2
    s_add_u32 s21, s21, s22
    s_lshl_b32 s21, s21, 13
    s_add_u32 s29, s21, 4096
    v_and_b32 v3, 31, v2
    v_lshrrev_b32 v4, 5, v2
    v_lshrrev_b32 v6, 4, v2
    v_and_b32 v7, 15, v2
    v_lshlrev_b32 v16, 2, v6
    v_xor_b32 v16, v16, v7
    v_lshlrev_b32 v16, 4, v16
    v_lshl_add_u32 v16, v6, 8, v16
    v_xor_b32 v17, v6, v7
    v_lshlrev_b32 v17, 4, v17
    v_lshl_add_u32 v17, v6, 8, v17
    v_xor_b32 v18, 64, v17
    v_xor_b32 v19, 128, v17
    v_xor_b32 v20, 192, v17
    s_lshl_b32 s23, s22, 13
    s_add_u32 s24, s23, 4096
    s_add_u32 m0, s23, 0x10000
    s_waitcnt lgkmcnt(0)
    s_and_b32 s5, s5, 0xffff
    s_and_b32 s9, s9, 0xffff
    s_and_b32 s13, s13, 0xffff
    s_and_b32 s17, s17, 0xffff
    buffer_load_dwordx4 v17, s[4:7], s21 offen offset:0 lds
    buffer_load_dwordx4 v18, s[4:7], s21 offen offset:1024 lds
    buffer_load_dwordx4 v19, s[4:7], s21 offen offset:2048 lds
    buffer_load_dwordx4 v20, s[4:7], s21 offen offset:3072 lds
    s_add_u32 m0, s24, 0x10000
    s_nop 0
    buffer_load_dwordx4 v17, s[4:7], s29 offen offset:0 lds
    buffer_load_dwordx4 v18, s[4:7], s29 offen offset:1024 lds
    buffer_load_dwordx4 v19, s[4:7], s29 offen offset:2048 lds
    buffer_load_dwordx4 v20, s[4:7], s29 offen offset:3072 lds
    s_add_u32 m0, s23, 0
    s_nop 0
    buffer_load_dwordx4 v16, s[8:11], s23 offen offset:0 lds
    buffer_load_dwordx4 v16, s[8:11], s23 offen offset:1024 lds
    buffer_load_dwordx4 v16, s[8:11], s23 offen offset:2048 lds
    buffer_load_dwordx4 v16, s[8:11], s23 offen offset:3072 lds
    s_add_u32 m0, s24, 0
    s_nop 0
    buffer_load_dwordx4 v16, s[8:11], s24 offen offset:0 lds
    buffer_load_dwordx4 v16, s[8:11], s24 offen offset:1024 lds
    buffer_load_dwordx4 v16, s[8:11], s24 offen offset:2048 lds
    buffer_load_dwordx4 v16, s[8:11], s24 offen offset:3072 lds
    v_mov_b32 v21, 0
    v_lshlrev_b32 v22, 2, v0
    s_lshl_b32 s28, s25, 7
    s_add_u32 s28, s28, 50331648
    v_cmp_gt_u32 vcc, 32, v0
    s_and_saveexec_b64 s[30:31], vcc
    s_cbranch_execz L_k1_nz
    buffer_store_dword v21, v22, s[16:19], s28 offen
L_k1_nz:
    s_mov_b64 exec, s[30:31]
    v_and_b32 v21, 15, v3
    v_xor_b32 v21, v21, v4
    v_lshlrev_b32 v21, 4, v21
    v_lshl_add_u32 v21, v3, 8, v21
    v_add_u32 v21, s23, v21
    v_add_u32 v21, 0x10000, v21
    v_lshrrev_b32 v17, 2, v7
    v_lshrrev_b32 v18, 1, v6
    v_and_b32 v19, 1, v6
    v_lshlrev_b32 v20, 6, v17
    v_lshl_add_u32 v20, v19, 5, v20
    v_and_b32 v22, 3, v7
    v_lshl_add_u32 v20, v22, 3, v20
    v_lshl_add_u32 v20, v17, 8, v20
    v_lshl_add_u32 v8, v18, 11, v20
    v_lshl_add_u32 v12, v18, 10, v20
    v_xor_b32 v9, 64, v8
    v_xor_b32 v13, 64, v12
    v_xor_b32 v10, 128, v8
    v_xor_b32 v14, 128, v12
    v_xor_b32 v11, 192, v8
    v_xor_b32 v15, 192, v12
    v_xor_b32 v225, 32, v21
    v_xor_b32 v226, 64, v21
    v_xor_b32 v227, 96, v21
    v_xor_b32 v228, 128, v21
    v_xor_b32 v229, 160, v21
    v_xor_b32 v230, 192, v21
    v_xor_b32 v231, 224, v21
    s_add_u32 s28, s21, 12582912
    s_add_u32 s29, s28, 4096
    v_xor_b32 v17, v6, v7
    v_lshlrev_b32 v17, 4, v17
    v_lshl_add_u32 v17, v6, 8, v17
    v_add_u32 v17, s23, v17
    v_add_u32 v17, 0x10000, v17
    v_xor_b32 v18, 64, v17
    v_xor_b32 v19, 128, v17
    v_xor_b32 v20, 192, v17
    v_lshlrev_b32 v30, 4, v2
    s_waitcnt vmcnt(8)
    ds_read_b128 v[64:67], v21
    ds_read_b128 v[68:71], v225
    ds_read_b128 v[72:75], v226
    ds_read_b128 v[76:79], v227
    ds_read_b128 v[80:83], v228
    ds_read_b128 v[84:87], v229
    ds_read_b128 v[88:91], v230
    ds_read_b128 v[92:95], v231
    s_cmp_eq_u32 s20, 2
    s_cbranch_scc1 L_k1_w
    s_add_u32 m0, s23, 32768
    s_nop 0
    buffer_load_dwordx4 v16, s[12:15], s23 offen offset:0 lds
    buffer_load_dwordx4 v16, s[12:15], s23 offen offset:1024 lds
    buffer_load_dwordx4 v16, s[12:15], s23 offen offset:2048 lds
    buffer_load_dwordx4 v16, s[12:15], s23 offen offset:3072 lds
    s_add_u32 m0, s24, 32768
    s_nop 0
    buffer_load_dwordx4 v16, s[12:15], s24 offen offset:0 lds
    buffer_load_dwordx4 v16, s[12:15], s24 offen offset:1024 lds
    buffer_load_dwordx4 v16, s[12:15], s24 offen offset:2048 lds
    buffer_load_dwordx4 v16, s[12:15], s24 offen offset:3072 lds
    s_waitcnt lgkmcnt(0)
    v_lshlrev_b32 v96, 16, v64
    v_and_b32 v97, 0xffff0000, v64
    v_lshlrev_b32 v98, 16, v65
    v_and_b32 v99, 0xffff0000, v65
    v_lshlrev_b32 v100, 16, v66
    v_and_b32 v101, 0xffff0000, v66
    v_lshlrev_b32 v102, 16, v67
    v_and_b32 v103, 0xffff0000, v67
    v_lshlrev_b32 v104, 16, v68
    v_and_b32 v105, 0xffff0000, v68
    v_lshlrev_b32 v106, 16, v69
    v_and_b32 v107, 0xffff0000, v69
    v_lshlrev_b32 v108, 16, v70
    v_and_b32 v109, 0xffff0000, v70
    v_lshlrev_b32 v110, 16, v71
    v_and_b32 v111, 0xffff0000, v71
    v_lshlrev_b32 v112, 16, v72
    v_and_b32 v113, 0xffff0000, v72
    v_lshlrev_b32 v114, 16, v73
    v_and_b32 v115, 0xffff0000, v73
    v_lshlrev_b32 v116, 16, v74
    v_and_b32 v117, 0xffff0000, v74
    v_lshlrev_b32 v118, 16, v75
    v_and_b32 v119, 0xffff0000, v75
    v_lshlrev_b32 v120, 16, v76
    v_and_b32 v121, 0xffff0000, v76
    v_lshlrev_b32 v122, 16, v77
    v_and_b32 v123, 0xffff0000, v77
    v_lshlrev_b32 v124, 16, v78
    v_and_b32 v125, 0xffff0000, v78
    v_lshlrev_b32 v126, 16, v79
    v_and_b32 v127, 0xffff0000, v79
    v_lshlrev_b32 v128, 16, v80
    v_and_b32 v129, 0xffff0000, v80
    v_lshlrev_b32 v130, 16, v81
    v_and_b32 v131, 0xffff0000, v81
    v_lshlrev_b32 v132, 16, v82
    v_and_b32 v133, 0xffff0000, v82
    v_lshlrev_b32 v134, 16, v83
    v_and_b32 v135, 0xffff0000, v83
    v_lshlrev_b32 v136, 16, v84
    v_and_b32 v137, 0xffff0000, v84
    v_lshlrev_b32 v138, 16, v85
    v_and_b32 v139, 0xffff0000, v85
    v_lshlrev_b32 v140, 16, v86
    v_and_b32 v141, 0xffff0000, v86
    v_lshlrev_b32 v142, 16, v87
    v_and_b32 v143, 0xffff0000, v87
    v_lshlrev_b32 v144, 16, v88
    v_and_b32 v145, 0xffff0000, v88
    v_lshlrev_b32 v146, 16, v89
    v_and_b32 v147, 0xffff0000, v89
    v_lshlrev_b32 v148, 16, v90
    v_and_b32 v149, 0xffff0000, v90
    v_lshlrev_b32 v150, 16, v91
    v_and_b32 v151, 0xffff0000, v91
    v_lshlrev_b32 v152, 16, v92
    v_and_b32 v153, 0xffff0000, v92
    v_lshlrev_b32 v154, 16, v93
    v_and_b32 v155, 0xffff0000, v93
    v_lshlrev_b32 v156, 16, v94
    v_and_b32 v157, 0xffff0000, v94
    v_lshlrev_b32 v158, 16, v95
    v_and_b32 v159, 0xffff0000, v95
    v_pk_add_f32 v[22:23], v[96:97], v[98:99]
    v_pk_add_f32 v[24:25], v[100:101], v[102:103]
    v_pk_add_f32 v[22:23], v[22:23], v[104:105]
    v_pk_add_f32 v[24:25], v[24:25], v[106:107]
    v_pk_add_f32 v[22:23], v[22:23], v[108:109]
    v_pk_add_f32 v[24:25], v[24:25], v[110:111]
    v_pk_add_f32 v[22:23], v[22:23], v[112:113]
    v_pk_add_f32 v[24:25], v[24:25], v[114:115]
    v_pk_add_f32 v[22:23], v[22:23], v[116:117]
    v_pk_add_f32 v[24:25], v[24:25], v[118:119]
    v_pk_add_f32 v[22:23], v[22:23], v[120:121]
    v_pk_add_f32 v[24:25], v[24:25], v[122:123]
    v_pk_add_f32 v[22:23], v[22:23], v[124:125]
    v_pk_add_f32 v[24:25], v[24:25], v[126:127]
    v_pk_add_f32 v[22:23], v[22:23], v[128:129]
    v_pk_add_f32 v[24:25], v[24:25], v[130:131]
    v_pk_add_f32 v[22:23], v[22:23], v[132:133]
    v_pk_add_f32 v[24:25], v[24:25], v[134:135]
    v_pk_add_f32 v[22:23], v[22:23], v[136:137]
    v_pk_add_f32 v[24:25], v[24:25], v[138:139]
    v_pk_add_f32 v[22:23], v[22:23], v[140:141]
    v_pk_add_f32 v[24:25], v[24:25], v[142:143]
    v_pk_add_f32 v[22:23], v[22:23], v[144:145]
    v_pk_add_f32 v[24:25], v[24:25], v[146:147]
    v_pk_add_f32 v[22:23], v[22:23], v[148:149]
    v_pk_add_f32 v[24:25], v[24:25], v[150:151]
    v_pk_add_f32 v[22:23], v[22:23], v[152:153]
    v_pk_add_f32 v[24:25], v[24:25], v[154:155]
    v_pk_add_f32 v[22:23], v[22:23], v[156:157]
    v_pk_add_f32 v[24:25], v[24:25], v[158:159]
    v_pk_add_f32 v[22:23], v[22:23], v[24:25]
    v_add_f32 v22, v22, v23
    v_mov_b32 v23, v22
    s_nop 1
    v_permlane32_swap_b32 v22, v23
    s_nop 1
    v_add_f32 v22, v22, v23
    v_mul_f32 v26, 0xbc000000, v22
    v_mov_b32 v27, v26
    v_pk_add_f32 v[96:97], v[96:97], v[26:27]
    v_pk_add_f32 v[98:99], v[98:99], v[26:27]
    v_pk_add_f32 v[100:101], v[100:101], v[26:27]
    v_pk_add_f32 v[102:103], v[102:103], v[26:27]
    v_pk_add_f32 v[104:105], v[104:105], v[26:27]
    v_pk_add_f32 v[106:107], v[106:107], v[26:27]
    v_pk_add_f32 v[108:109], v[108:109], v[26:27]
    v_pk_add_f32 v[110:111], v[110:111], v[26:27]
    v_pk_add_f32 v[112:113], v[112:113], v[26:27]
    v_pk_add_f32 v[114:115], v[114:115], v[26:27]
    v_pk_add_f32 v[116:117], v[116:117], v[26:27]
    v_pk_add_f32 v[118:119], v[118:119], v[26:27]
    v_pk_add_f32 v[120:121], v[120:121], v[26:27]
    v_pk_add_f32 v[122:123], v[122:123], v[26:27]
    v_pk_add_f32 v[124:125], v[124:125], v[26:27]
    v_pk_add_f32 v[126:127], v[126:127], v[26:27]
    v_pk_add_f32 v[128:129], v[128:129], v[26:27]
    v_pk_add_f32 v[130:131], v[130:131], v[26:27]
    v_pk_add_f32 v[132:133], v[132:133], v[26:27]
    v_pk_add_f32 v[134:135], v[134:135], v[26:27]
    v_pk_add_f32 v[136:137], v[136:137], v[26:27]
    v_pk_add_f32 v[138:139], v[138:139], v[26:27]
    v_pk_add_f32 v[140:141], v[140:141], v[26:27]
    v_pk_add_f32 v[142:143], v[142:143], v[26:27]
    v_pk_add_f32 v[144:145], v[144:145], v[26:27]
    v_pk_add_f32 v[146:147], v[146:147], v[26:27]
    v_pk_add_f32 v[148:149], v[148:149], v[26:27]
    v_pk_add_f32 v[150:151], v[150:151], v[26:27]
    v_pk_add_f32 v[152:153], v[152:153], v[26:27]
    v_pk_add_f32 v[154:155], v[154:155], v[26:27]
    v_pk_add_f32 v[156:157], v[156:157], v[26:27]
    v_pk_add_f32 v[158:159], v[158:159], v[26:27]
    v_pk_mul_f32 v[22:23], v[96:97], v[96:97]
    v_pk_mul_f32 v[24:25], v[98:99], v[98:99]
    v_pk_fma_f32 v[22:23], v[100:101], v[100:101], v[22:23]
    v_pk_fma_f32 v[24:25], v[102:103], v[102:103], v[24:25]
    v_pk_fma_f32 v[22:23], v[104:105], v[104:105], v[22:23]
    v_pk_fma_f32 v[24:25], v[106:107], v[106:107], v[24:25]
    v_pk_fma_f32 v[22:23], v[108:109], v[108:109], v[22:23]
    v_pk_fma_f32 v[24:25], v[110:111], v[110:111], v[24:25]
    v_pk_fma_f32 v[22:23], v[112:113], v[112:113], v[22:23]
    v_pk_fma_f32 v[24:25], v[114:115], v[114:115], v[24:25]
    v_pk_fma_f32 v[22:23], v[116:117], v[116:117], v[22:23]
    v_pk_fma_f32 v[24:25], v[118:119], v[118:119], v[24:25]
    v_pk_fma_f32 v[22:23], v[120:121], v[120:121], v[22:23]
    v_pk_fma_f32 v[24:25], v[122:123], v[122:123], v[24:25]
    v_pk_fma_f32 v[22:23], v[124:125], v[124:125], v[22:23]
    v_pk_fma_f32 v[24:25], v[126:127], v[126:127], v[24:25]
    v_pk_fma_f32 v[22:23], v[128:129], v[128:129], v[22:23]
    v_pk_fma_f32 v[24:25], v[130:131], v[130:131], v[24:25]
    v_pk_fma_f32 v[22:23], v[132:133], v[132:133], v[22:23]
    v_pk_fma_f32 v[24:25], v[134:135], v[134:135], v[24:25]
    v_pk_fma_f32 v[22:23], v[136:137], v[136:137], v[22:23]
    v_pk_fma_f32 v[24:25], v[138:139], v[138:139], v[24:25]
    v_pk_fma_f32 v[22:23], v[140:141], v[140:141], v[22:23]
    v_pk_fma_f32 v[24:25], v[142:143], v[142:143], v[24:25]
    v_pk_fma_f32 v[22:23], v[144:145], v[144:145], v[22:23]
    v_pk_fma_f32 v[24:25], v[146:147], v[146:147], v[24:25]
    v_pk_fma_f32 v[22:23], v[148:149], v[148:149], v[22:23]
    v_pk_fma_f32 v[24:25], v[150:151], v[150:151], v[24:25]
    v_pk_fma_f32 v[22:23], v[152:153], v[152:153], v[22:23]
    v_pk_fma_f32 v[24:25], v[154:155], v[154:155], v[24:25]
    v_pk_fma_f32 v[22:23], v[156:157], v[156:157], v[22:23]
    v_pk_fma_f32 v[24:25], v[158:159], v[158:159], v[24:25]
    v_pk_add_f32 v[22:23], v[22:23], v[24:25]
    v_add_f32 v22, v22, v23
    v_mov_b32 v23, v22
    s_nop 1
    v_permlane32_swap_b32 v22, v23
    s_nop 1
    v_add_f32 v22, v22, v23
    v_mul_f32 v22, 0x3c000000, v22
    v_cvt_pk_bf16_f32 v22, v22, v22
    v_lshlrev_b32 v22, 16, v22
    v_add_f32 v22, 0x3727c5ac, v22
    v_cvt_pk_bf16_f32 v22, v22, v22
    v_lshlrev_b32 v22, 16, v22
    v_sqrt_f32 v22, v22
    v_cvt_pk_bf16_f32 v24, v26, v26
    v_cvt_pk_bf16_f32 v22, v22, v22
    v_lshlrev_b32 v22, 16, v22
    v_rcp_f32 v28, v22
    v_lshlrev_b32 v24, 16, v24
    v_sub_f32 v24, v24, v26
    v_mov_b32 v29, v28
    v_mul_f32 v24, v24, v28
    v_mov_b32 v25, v24
    v_pk_fma_f32 v[96:97], v[96:97], v[28:29], v[24:25]
    v_pk_fma_f32 v[98:99], v[98:99], v[28:29], v[24:25]
    v_cvt_pk_bf16_f32 v32, v96, v97
    v_pk_fma_f32 v[100:101], v[100:101], v[28:29], v[24:25]
    v_cvt_pk_bf16_f32 v33, v98, v99
    v_pk_fma_f32 v[102:103], v[102:103], v[28:29], v[24:25]
    v_cvt_pk_bf16_f32 v34, v100, v101
    v_pk_fma_f32 v[104:105], v[104:105], v[28:29], v[24:25]
    v_cvt_pk_bf16_f32 v35, v102, v103
    v_pk_fma_f32 v[106:107], v[106:107], v[28:29], v[24:25]
    v_cvt_pk_bf16_f32 v36, v104, v105
    ds_write_b128 v21, v[32:35]
    v_pk_fma_f32 v[108:109], v[108:109], v[28:29], v[24:25]
    v_cvt_pk_bf16_f32 v37, v106, v107
    v_pk_fma_f32 v[110:111], v[110:111], v[28:29], v[24:25]
    v_cvt_pk_bf16_f32 v38, v108, v109
    v_pk_fma_f32 v[112:113], v[112:113], v[28:29], v[24:25]
    v_cvt_pk_bf16_f32 v39, v110, v111
    v_pk_fma_f32 v[114:115], v[114:115], v[28:29], v[24:25]
    v_cvt_pk_bf16_f32 v40, v112, v113
    ds_write_b128 v225, v[36:39]
    v_pk_fma_f32 v[116:117], v[116:117], v[28:29], v[24:25]
    v_cvt_pk_bf16_f32 v41, v114, v115
    v_pk_fma_f32 v[118:119], v[118:119], v[28:29], v[24:25]
    v_cvt_pk_bf16_f32 v42, v116, v117
    v_pk_fma_f32 v[120:121], v[120:121], v[28:29], v[24:25]
    v_cvt_pk_bf16_f32 v43, v118, v119
    v_pk_fma_f32 v[122:123], v[122:123], v[28:29], v[24:25]
    v_cvt_pk_bf16_f32 v44, v120, v121
    ds_write_b128 v226, v[40:43]
    v_pk_fma_f32 v[124:125], v[124:125], v[28:29], v[24:25]
    v_cvt_pk_bf16_f32 v45, v122, v123
    v_pk_fma_f32 v[126:127], v[126:127], v[28:29], v[24:25]
    v_cvt_pk_bf16_f32 v46, v124, v125
    v_pk_fma_f32 v[128:129], v[128:129], v[28:29], v[24:25]
    v_cvt_pk_bf16_f32 v47, v126, v127
    v_pk_fma_f32 v[130:131], v[130:131], v[28:29], v[24:25]
    v_cvt_pk_bf16_f32 v48, v128, v129
    ds_write_b128 v227, v[44:47]
    v_pk_fma_f32 v[132:133], v[132:133], v[28:29], v[24:25]
    v_cvt_pk_bf16_f32 v49, v130, v131
    v_pk_fma_f32 v[134:135], v[134:135], v[28:29], v[24:25]
    v_cvt_pk_bf16_f32 v50, v132, v133
    v_pk_fma_f32 v[136:137], v[136:137], v[28:29], v[24:25]
    v_cvt_pk_bf16_f32 v51, v134, v135
    v_pk_fma_f32 v[138:139], v[138:139], v[28:29], v[24:25]
    v_cvt_pk_bf16_f32 v52, v136, v137
    ds_write_b128 v228, v[48:51]
    v_pk_fma_f32 v[140:141], v[140:141], v[28:29], v[24:25]
    v_cvt_pk_bf16_f32 v53, v138, v139
    v_pk_fma_f32 v[142:143], v[142:143], v[28:29], v[24:25]
    v_cvt_pk_bf16_f32 v54, v140, v141
    v_pk_fma_f32 v[144:145], v[144:145], v[28:29], v[24:25]
    v_cvt_pk_bf16_f32 v55, v142, v143
    v_pk_fma_f32 v[146:147], v[146:147], v[28:29], v[24:25]
    v_cvt_pk_bf16_f32 v56, v144, v145
    ds_write_b128 v229, v[52:55]
    v_pk_fma_f32 v[148:149], v[148:149], v[28:29], v[24:25]
    v_cvt_pk_bf16_f32 v57, v146, v147
    v_pk_fma_f32 v[150:151], v[150:151], v[28:29], v[24:25]
    v_cvt_pk_bf16_f32 v58, v148, v149
    v_pk_fma_f32 v[152:153], v[152:153], v[28:29], v[24:25]
    v_cvt_pk_bf16_f32 v59, v150, v151
    v_pk_fma_f32 v[154:155], v[154:155], v[28:29], v[24:25]
    v_cvt_pk_bf16_f32 v60, v152, v153
    ds_write_b128 v230, v[56:59]
    v_pk_fma_f32 v[156:157], v[156:157], v[28:29], v[24:25]
    v_cvt_pk_bf16_f32 v61, v154, v155
    v_pk_fma_f32 v[158:159], v[158:159], v[28:29], v[24:25]
    v_cvt_pk_bf16_f32 v62, v156, v157
    v_cvt_pk_bf16_f32 v63, v158, v159
    ds_write_b128 v231, v[60:63]
    s_mov_b32 s26, 0x3e0293ee
    s_cmp_eq_u32 s20, 0
    s_cbranch_scc1 L_k1_noh
    s_waitcnt vmcnt(8) lgkmcnt(0)
    s_barrier
    ds_read_b128 v[192:195], v17 offset:0
    ds_read_b128 v[196:199], v18 offset:1024
    ds_read_b128 v[200:203], v19 offset:2048
    ds_read_b128 v[204:207], v20 offset:3072
    ds_read_b128 v[208:211], v17 offset:4096
    ds_read_b128 v[212:215], v18 offset:5120
    ds_read_b128 v[216:219], v19 offset:6144
    ds_read_b128 v[220:223], v20 offset:7168
    ds_read_b64_tr_b16 v[96:97], v8 offset:0
    ds_read_b64_tr_b16 v[98:99], v8 offset:1024
    ds_read_b64_tr_b16 v[100:101], v8 offset:4096
    ds_read_b64_tr_b16 v[102:103], v8 offset:5120
    ds_read_b64_tr_b16 v[104:105], v8 offset:8192
    ds_read_b64_tr_b16 v[106:107], v8 offset:9216
    ds_read_b64_tr_b16 v[108:109], v8 offset:12288
    ds_read_b64_tr_b16 v[110:111], v8 offset:13312
    ds_read_b64_tr_b16 v[112:113], v8 offset:16384
    ds_read_b64_tr_b16 v[114:115], v8 offset:17408
    ds_read_b64_tr_b16 v[116:117], v8 offset:20480
    ds_read_b64_tr_b16 v[118:119], v8 offset:21504
    ds_read_b64_tr_b16 v[120:121], v8 offset:24576
    ds_read_b64_tr_b16 v[122:123], v8 offset:25600
    ds_read_b64_tr_b16 v[124:125], v8 offset:28672
    ds_read_b64_tr_b16 v[126:127], v8 offset:29696
    s_waitcnt lgkmcnt(14)
    v_mfma_f32_32x32x16_bf16 v[160:175], v[96:99], v[32:35], 0
    ds_read_b64_tr_b16 v[128:129], v9 offset:0
    ds_read_b64_tr_b16 v[130:131], v9 offset:1024
    s_waitcnt lgkmcnt(14)
    v_mfma_f32_32x32x16_bf16 v[160:175], v[100:103], v[36:39], v[160:175]
    ds_read_b64_tr_b16 v[132:133], v9 offset:4096
    ds_read_b64_tr_b16 v[134:135], v9 offset:5120
    s_waitcnt lgkmcnt(14)
    v_mfma_f32_32x32x16_bf16 v[160:175], v[104:107], v[40:43], v[160:175]
    ds_read_b64_tr_b16 v[136:137], v9 offset:8192
    ds_read_b64_tr_b16 v[138:139], v9 offset:9216
    buffer_store_dwordx4 v[192:195], v30, s[16:19], s28 offen offset:0 sc1
    buffer_store_dwordx4 v[196:199], v30, s[16:19], s28 offen offset:1024 sc1
    s_waitcnt lgkmcnt(14)
    v_mfma_f32_32x32x16_bf16 v[160:175], v[108:111], v[44:47], v[160:175]
    ds_read_b64_tr_b16 v[140:141], v9 offset:12288
    ds_read_b64_tr_b16 v[142:143], v9 offset:13312
    buffer_store_dwordx4 v[200:203], v30, s[16:19], s28 offen offset:2048 sc1
    buffer_store_dwordx4 v[204:207], v30, s[16:19], s28 offen offset:3072 sc1
    s_waitcnt lgkmcnt(14)
    v_mfma_f32_32x32x16_bf16 v[160:175], v[112:115], v[48:51], v[160:175]
    ds_read_b64_tr_b16 v[144:145], v9 offset:16384
    ds_read_b64_tr_b16 v[146:147], v9 offset:17408
    buffer_store_dwordx4 v[208:211], v30, s[16:19], s29 offen offset:0 sc1
    buffer_store_dwordx4 v[212:215], v30, s[16:19], s29 offen offset:1024 sc1
    s_waitcnt lgkmcnt(14)
    v_mfma_f32_32x32x16_bf16 v[160:175], v[116:119], v[52:55], v[160:175]
    ds_read_b64_tr_b16 v[148:149], v9 offset:20480
    ds_read_b64_tr_b16 v[150:151], v9 offset:21504
    buffer_store_dwordx4 v[216:219], v30, s[16:19], s29 offen offset:2048 sc1
    buffer_store_dwordx4 v[220:223], v30, s[16:19], s29 offen offset:3072 sc1
    s_waitcnt lgkmcnt(14)
    v_mfma_f32_32x32x16_bf16 v[160:175], v[120:123], v[56:59], v[160:175]
    ds_read_b64_tr_b16 v[152:153], v9 offset:24576
    ds_read_b64_tr_b16 v[154:155], v9 offset:25600
    s_waitcnt lgkmcnt(14)
    v_mfma_f32_32x32x16_bf16 v[160:175], v[124:127], v[60:63], v[160:175]
    ds_read_b64_tr_b16 v[156:157], v9 offset:28672
    ds_read_b64_tr_b16 v[158:159], v9 offset:29696
    s_waitcnt lgkmcnt(14)
    v_mfma_f32_32x32x16_bf16 v[176:191], v[128:131], v[32:35], 0
    ds_read_b64_tr_b16 v[96:97], v10 offset:0
    ds_read_b64_tr_b16 v[98:99], v10 offset:1024
    s_waitcnt lgkmcnt(14)
    v_mfma_f32_32x32x16_bf16 v[176:191], v[132:135], v[36:39], v[176:191]
    ds_read_b64_tr_b16 v[100:101], v10 offset:4096
    ds_read_b64_tr_b16 v[102:103], v10 offset:5120
    s_waitcnt lgkmcnt(14)
    v_mfma_f32_32x32x16_bf16 v[176:191], v[136:139], v[40:43], v[176:191]
    ds_read_b64_tr_b16 v[104:105], v10 offset:8192
    ds_read_b64_tr_b16 v[106:107], v10 offset:9216
    v_cvt_pk_bf16_f32 v64, v160, v161
    v_cvt_pk_bf16_f32 v65, v162, v163
    s_waitcnt lgkmcnt(14)
    v_mfma_f32_32x32x16_bf16 v[176:191], v[140:143], v[44:47], v[176:191]
    ds_read_b64_tr_b16 v[108:109], v10 offset:12288
    ds_read_b64_tr_b16 v[110:111], v10 offset:13312
    v_cvt_pk_bf16_f32 v66, v164, v165
    v_cvt_pk_bf16_f32 v67, v166, v167
    s_waitcnt lgkmcnt(14)
    v_mfma_f32_32x32x16_bf16 v[176:191], v[144:147], v[48:51], v[176:191]
    ds_read_b64_tr_b16 v[112:113], v10 offset:16384
    ds_read_b64_tr_b16 v[114:115], v10 offset:17408
    v_cvt_pk_bf16_f32 v68, v168, v169
    v_cvt_pk_bf16_f32 v69, v170, v171
    s_waitcnt lgkmcnt(14)
    v_mfma_f32_32x32x16_bf16 v[176:191], v[148:151], v[52:55], v[176:191]
    ds_read_b64_tr_b16 v[116:117], v10 offset:20480
    ds_read_b64_tr_b16 v[118:119], v10 offset:21504
    v_cvt_pk_bf16_f32 v70, v172, v173
    v_cvt_pk_bf16_f32 v71, v174, v175
    s_waitcnt lgkmcnt(14)
    v_mfma_f32_32x32x16_bf16 v[176:191], v[152:155], v[56:59], v[176:191]
    ds_read_b64_tr_b16 v[120:121], v10 offset:24576
    ds_read_b64_tr_b16 v[122:123], v10 offset:25600
    s_waitcnt lgkmcnt(14)
    v_mfma_f32_32x32x16_bf16 v[176:191], v[156:159], v[60:63], v[176:191]
    ds_read_b64_tr_b16 v[124:125], v10 offset:28672
    ds_read_b64_tr_b16 v[126:127], v10 offset:29696
    s_waitcnt lgkmcnt(14)
    v_mfma_f32_32x32x16_bf16 v[192:207], v[96:99], v[32:35], 0
    ds_read_b64_tr_b16 v[128:129], v11 offset:0
    ds_read_b64_tr_b16 v[130:131], v11 offset:1024
    s_waitcnt lgkmcnt(14)
    v_mfma_f32_32x32x16_bf16 v[192:207], v[100:103], v[36:39], v[192:207]
    ds_read_b64_tr_b16 v[132:133], v11 offset:4096
    ds_read_b64_tr_b16 v[134:135], v11 offset:5120
    s_waitcnt lgkmcnt(14)
    v_mfma_f32_32x32x16_bf16 v[192:207], v[104:107], v[40:43], v[192:207]
    ds_read_b64_tr_b16 v[136:137], v11 offset:8192
    ds_read_b64_tr_b16 v[138:139], v11 offset:9216
    v_cvt_pk_bf16_f32 v72, v176, v177
    v_cvt_pk_bf16_f32 v73, v178, v179
    s_waitcnt lgkmcnt(14)
    v_mfma_f32_32x32x16_bf16 v[192:207], v[108:111], v[44:47], v[192:207]
    ds_read_b64_tr_b16 v[140:141], v11 offset:12288
    ds_read_b64_tr_b16 v[142:143], v11 offset:13312
    v_cvt_pk_bf16_f32 v74, v180, v181
    v_cvt_pk_bf16_f32 v75, v182, v183
    s_waitcnt lgkmcnt(14)
    v_mfma_f32_32x32x16_bf16 v[192:207], v[112:115], v[48:51], v[192:207]
    ds_read_b64_tr_b16 v[144:145], v11 offset:16384
    ds_read_b64_tr_b16 v[146:147], v11 offset:17408
    v_cvt_pk_bf16_f32 v76, v184, v185
    v_cvt_pk_bf16_f32 v77, v186, v187
    s_waitcnt lgkmcnt(14)
    v_mfma_f32_32x32x16_bf16 v[192:207], v[116:119], v[52:55], v[192:207]
    ds_read_b64_tr_b16 v[148:149], v11 offset:20480
    ds_read_b64_tr_b16 v[150:151], v11 offset:21504
    v_cvt_pk_bf16_f32 v78, v188, v189
    v_cvt_pk_bf16_f32 v79, v190, v191
    s_waitcnt lgkmcnt(14)
    v_mfma_f32_32x32x16_bf16 v[192:207], v[120:123], v[56:59], v[192:207]
    ds_read_b64_tr_b16 v[152:153], v11 offset:24576
    ds_read_b64_tr_b16 v[154:155], v11 offset:25600
    s_waitcnt lgkmcnt(14)
    v_mfma_f32_32x32x16_bf16 v[192:207], v[124:127], v[60:63], v[192:207]
    ds_read_b64_tr_b16 v[156:157], v11 offset:28672
    ds_read_b64_tr_b16 v[158:159], v11 offset:29696
    s_waitcnt lgkmcnt(14)
    v_mfma_f32_32x32x16_bf16 v[208:223], v[128:131], v[32:35], 0
    s_waitcnt lgkmcnt(12)
    v_mfma_f32_32x32x16_bf16 v[208:223], v[132:135], v[36:39], v[208:223]
    s_waitcnt lgkmcnt(10)
    v_mfma_f32_32x32x16_bf16 v[208:223], v[136:139], v[40:43], v[208:223]
    v_cvt_pk_bf16_f32 v80, v192, v193
    v_cvt_pk_bf16_f32 v81, v194, v195
    s_waitcnt lgkmcnt(8)
    v_mfma_f32_32x32x16_bf16 v[208:223], v[140:143], v[44:47], v[208:223]
    v_cvt_pk_bf16_f32 v82, v196, v197
    v_cvt_pk_bf16_f32 v83, v198, v199
    s_waitcnt lgkmcnt(6)
    v_mfma_f32_32x32x16_bf16 v[208:223], v[144:147], v[48:51], v[208:223]
    v_cvt_pk_bf16_f32 v84, v200, v201
    v_cvt_pk_bf16_f32 v85, v202, v203
    s_waitcnt lgkmcnt(4)
    v_mfma_f32_32x32x16_bf16 v[208:223], v[148:151], v[52:55], v[208:223]
    v_cvt_pk_bf16_f32 v86, v204, v205
    v_cvt_pk_bf16_f32 v87, v206, v207
    s_waitcnt lgkmcnt(2)
    v_mfma_f32_32x32x16_bf16 v[208:223], v[152:155], v[56:59], v[208:223]
    s_waitcnt lgkmcnt(0)
    v_mfma_f32_32x32x16_bf16 v[208:223], v[156:159], v[60:63], v[208:223]
    s_branch L_k1_second
L_k1_noh:
    s_waitcnt vmcnt(8) lgkmcnt(0)
    s_barrier
    ds_read_b64_tr_b16 v[96:97], v8 offset:0
    ds_read_b64_tr_b16 v[98:99], v8 offset:1024
    ds_read_b64_tr_b16 v[100:101], v8 offset:4096
    ds_read_b64_tr_b16 v[102:103], v8 offset:5120
    ds_read_b64_tr_b16 v[104:105], v8 offset:8192
    ds_read_b64_tr_b16 v[106:107], v8 offset:9216
    ds_read_b64_tr_b16 v[108:109], v8 offset:12288
    ds_read_b64_tr_b16 v[110:111], v8 offset:13312
    ds_read_b64_tr_b16 v[112:113], v8 offset:16384
    ds_read_b64_tr_b16 v[114:115], v8 offset:17408
    ds_read_b64_tr_b16 v[116:117], v8 offset:20480
    ds_read_b64_tr_b16 v[118:119], v8 offset:21504
    ds_read_b64_tr_b16 v[120:121], v8 offset:24576
    ds_read_b64_tr_b16 v[122:123], v8 offset:25600
    ds_read_b64_tr_b16 v[124:125], v8 offset:28672
    ds_read_b64_tr_b16 v[126:127], v8 offset:29696
    s_waitcnt lgkmcnt(14)
    v_mfma_f32_32x32x16_bf16 v[160:175], v[96:99], v[32:35], 0
    ds_read_b64_tr_b16 v[128:129], v9 offset:0
    ds_read_b64_tr_b16 v[130:131], v9 offset:1024
    s_waitcnt lgkmcnt(14)
    v_mfma_f32_32x32x16_bf16 v[160:175], v[100:103], v[36:39], v[160:175]
    ds_read_b64_tr_b16 v[132:133], v9 offset:4096
    ds_read_b64_tr_b16 v[134:135], v9 offset:5120
    s_waitcnt lgkmcnt(14)
    v_mfma_f32_32x32x16_bf16 v[160:175], v[104:107], v[40:43], v[160:175]
    ds_read_b64_tr_b16 v[136:137], v9 offset:8192
    ds_read_b64_tr_b16 v[138:139], v9 offset:9216
    s_waitcnt lgkmcnt(14)
    v_mfma_f32_32x32x16_bf16 v[160:175], v[108:111], v[44:47], v[160:175]
    ds_read_b64_tr_b16 v[140:141], v9 offset:12288
    ds_read_b64_tr_b16 v[142:143], v9 offset:13312
    s_waitcnt lgkmcnt(14)
    v_mfma_f32_32x32x16_bf16 v[160:175], v[112:115], v[48:51], v[160:175]
    ds_read_b64_tr_b16 v[144:145], v9 offset:16384
    ds_read_b64_tr_b16 v[146:147], v9 offset:17408
    s_waitcnt lgkmcnt(14)
    v_mfma_f32_32x32x16_bf16 v[160:175], v[116:119], v[52:55], v[160:175]
    ds_read_b64_tr_b16 v[148:149], v9 offset:20480
    ds_read_b64_tr_b16 v[150:151], v9 offset:21504
    s_waitcnt lgkmcnt(14)
    v_mfma_f32_32x32x16_bf16 v[160:175], v[120:123], v[56:59], v[160:175]
    ds_read_b64_tr_b16 v[152:153], v9 offset:24576
    ds_read_b64_tr_b16 v[154:155], v9 offset:25600
    s_waitcnt lgkmcnt(14)
    v_mfma_f32_32x32x16_bf16 v[160:175], v[124:127], v[60:63], v[160:175]
    ds_read_b64_tr_b16 v[156:157], v9 offset:28672
    ds_read_b64_tr_b16 v[158:159], v9 offset:29696
    s_waitcnt lgkmcnt(14)
    v_mfma_f32_32x32x16_bf16 v[176:191], v[128:131], v[32:35], 0
    ds_read_b64_tr_b16 v[96:97], v10 offset:0
    ds_read_b64_tr_b16 v[98:99], v10 offset:1024
    s_waitcnt lgkmcnt(14)
    v_mfma_f32_32x32x16_bf16 v[176:191], v[132:135], v[36:39], v[176:191]
    ds_read_b64_tr_b16 v[100:101], v10 offset:4096
    ds_read_b64_tr_b16 v[102:103], v10 offset:5120
    s_waitcnt lgkmcnt(14)
    v_mfma_f32_32x32x16_bf16 v[176:191], v[136:139], v[40:43], v[176:191]
    ds_read_b64_tr_b16 v[104:105], v10 offset:8192
    ds_read_b64_tr_b16 v[106:107], v10 offset:9216
    v_mul_f32 v160, s26, v160
    v_mul_f32 v161, s26, v161
    v_cvt_pk_bf16_f32 v64, v160, v161
    v_mul_f32 v162, s26, v162
    s_waitcnt lgkmcnt(14)
    v_mfma_f32_32x32x16_bf16 v[176:191], v[140:143], v[44:47], v[176:191]
    ds_read_b64_tr_b16 v[108:109], v10 offset:12288
    ds_read_b64_tr_b16 v[110:111], v10 offset:13312
    v_mul_f32 v163, s26, v163
    v_cvt_pk_bf16_f32 v65, v162, v163
    v_mul_f32 v164, s26, v164
    v_mul_f32 v165, s26, v165
    s_waitcnt lgkmcnt(14)
    v_mfma_f32_32x32x16_bf16 v[176:191], v[144:147], v[48:51], v[176:191]
    ds_read_b64_tr_b16 v[112:113], v10 offset:16384
    ds_read_b64_tr_b16 v[114:115], v10 offset:17408
    v_cvt_pk_bf16_f32 v66, v164, v165
    v_mul_f32 v166, s26, v166
    v_mul_f32 v167, s26, v167
    v_cvt_pk_bf16_f32 v67, v166, v167
    s_waitcnt lgkmcnt(14)
    v_mfma_f32_32x32x16_bf16 v[176:191], v[148:151], v[52:55], v[176:191]
    ds_read_b64_tr_b16 v[116:117], v10 offset:20480
    ds_read_b64_tr_b16 v[118:119], v10 offset:21504
    v_mul_f32 v168, s26, v168
    v_mul_f32 v169, s26, v169
    v_cvt_pk_bf16_f32 v68, v168, v169
    v_mul_f32 v170, s26, v170
    s_waitcnt lgkmcnt(14)
    v_mfma_f32_32x32x16_bf16 v[176:191], v[152:155], v[56:59], v[176:191]
    ds_read_b64_tr_b16 v[120:121], v10 offset:24576
    ds_read_b64_tr_b16 v[122:123], v10 offset:25600
    v_mul_f32 v171, s26, v171
    v_cvt_pk_bf16_f32 v69, v170, v171
    v_mul_f32 v172, s26, v172
    v_mul_f32 v173, s26, v173
    s_waitcnt lgkmcnt(14)
    v_mfma_f32_32x32x16_bf16 v[176:191], v[156:159], v[60:63], v[176:191]
    ds_read_b64_tr_b16 v[124:125], v10 offset:28672
    ds_read_b64_tr_b16 v[126:127], v10 offset:29696
    v_cvt_pk_bf16_f32 v70, v172, v173
    v_mul_f32 v174, s26, v174
    v_mul_f32 v175, s26, v175
    v_cvt_pk_bf16_f32 v71, v174, v175
    s_waitcnt lgkmcnt(14)
    v_mfma_f32_32x32x16_bf16 v[192:207], v[96:99], v[32:35], 0
    ds_read_b64_tr_b16 v[128:129], v11 offset:0
    ds_read_b64_tr_b16 v[130:131], v11 offset:1024
    s_waitcnt lgkmcnt(14)
    v_mfma_f32_32x32x16_bf16 v[192:207], v[100:103], v[36:39], v[192:207]
    ds_read_b64_tr_b16 v[132:133], v11 offset:4096
    ds_read_b64_tr_b16 v[134:135], v11 offset:5120
    s_waitcnt lgkmcnt(14)
    v_mfma_f32_32x32x16_bf16 v[192:207], v[104:107], v[40:43], v[192:207]
    ds_read_b64_tr_b16 v[136:137], v11 offset:8192
    ds_read_b64_tr_b16 v[138:139], v11 offset:9216
    v_mul_f32 v176, s26, v176
    v_mul_f32 v177, s26, v177
    v_cvt_pk_bf16_f32 v72, v176, v177
    v_mul_f32 v178, s26, v178
    s_waitcnt lgkmcnt(14)
    v_mfma_f32_32x32x16_bf16 v[192:207], v[108:111], v[44:47], v[192:207]
    ds_read_b64_tr_b16 v[140:141], v11 offset:12288
    ds_read_b64_tr_b16 v[142:143], v11 offset:13312
    v_mul_f32 v179, s26, v179
    v_cvt_pk_bf16_f32 v73, v178, v179
    v_mul_f32 v180, s26, v180
    v_mul_f32 v181, s26, v181
    s_waitcnt lgkmcnt(14)
    v_mfma_f32_32x32x16_bf16 v[192:207], v[112:115], v[48:51], v[192:207]
    ds_read_b64_tr_b16 v[144:145], v11 offset:16384
    ds_read_b64_tr_b16 v[146:147], v11 offset:17408
    v_cvt_pk_bf16_f32 v74, v180, v181
    v_mul_f32 v182, s26, v182
    v_mul_f32 v183, s26, v183
    v_cvt_pk_bf16_f32 v75, v182, v183
    s_waitcnt lgkmcnt(14)
    v_mfma_f32_32x32x16_bf16 v[192:207], v[116:119], v[52:55], v[192:207]
    ds_read_b64_tr_b16 v[148:149], v11 offset:20480
    ds_read_b64_tr_b16 v[150:151], v11 offset:21504
    v_mul_f32 v184, s26, v184
    v_mul_f32 v185, s26, v185
    v_cvt_pk_bf16_f32 v76, v184, v185
    v_mul_f32 v186, s26, v186
    s_waitcnt lgkmcnt(14)
    v_mfma_f32_32x32x16_bf16 v[192:207], v[120:123], v[56:59], v[192:207]
    ds_read_b64_tr_b16 v[152:153], v11 offset:24576
    ds_read_b64_tr_b16 v[154:155], v11 offset:25600
    v_mul_f32 v187, s26, v187
    v_cvt_pk_bf16_f32 v77, v186, v187
    v_mul_f32 v188, s26, v188
    v_mul_f32 v189, s26, v189
    s_waitcnt lgkmcnt(14)
    v_mfma_f32_32x32x16_bf16 v[192:207], v[124:127], v[60:63], v[192:207]
    ds_read_b64_tr_b16 v[156:157], v11 offset:28672
    ds_read_b64_tr_b16 v[158:159], v11 offset:29696
    v_cvt_pk_bf16_f32 v78, v188, v189
    v_mul_f32 v190, s26, v190
    v_mul_f32 v191, s26, v191
    v_cvt_pk_bf16_f32 v79, v190, v191
    s_waitcnt lgkmcnt(14)
    v_mfma_f32_32x32x16_bf16 v[208:223], v[128:131], v[32:35], 0
    s_waitcnt lgkmcnt(12)
    v_mfma_f32_32x32x16_bf16 v[208:223], v[132:135], v[36:39], v[208:223]
    s_waitcnt lgkmcnt(10)
    v_mfma_f32_32x32x16_bf16 v[208:223], v[136:139], v[40:43], v[208:223]
    v_mul_f32 v192, s26, v192
    v_mul_f32 v193, s26, v193
    v_cvt_pk_bf16_f32 v80, v192, v193
    v_mul_f32 v194, s26, v194
    s_waitcnt lgkmcnt(8)
    v_mfma_f32_32x32x16_bf16 v[208:223], v[140:143], v[44:47], v[208:223]
    v_mul_f32 v195, s26, v195
    v_cvt_pk_bf16_f32 v81, v194, v195
    v_mul_f32 v196, s26, v196
    v_mul_f32 v197, s26, v197
    s_waitcnt lgkmcnt(6)
    v_mfma_f32_32x32x16_bf16 v[208:223], v[144:147], v[48:51], v[208:223]
    v_cvt_pk_bf16_f32 v82, v196, v197
    v_mul_f32 v198, s26, v198
    v_mul_f32 v199, s26, v199
    v_cvt_pk_bf16_f32 v83, v198, v199
    s_waitcnt lgkmcnt(4)
    v_mfma_f32_32x32x16_bf16 v[208:223], v[148:151], v[52:55], v[208:223]
    v_mul_f32 v200, s26, v200
    v_mul_f32 v201, s26, v201
    v_cvt_pk_bf16_f32 v84, v200, v201
    v_mul_f32 v202, s26, v202
    s_waitcnt lgkmcnt(2)
    v_mfma_f32_32x32x16_bf16 v[208:223], v[152:155], v[56:59], v[208:223]
    v_mul_f32 v203, s26, v203
    v_cvt_pk_bf16_f32 v85, v202, v203
    v_mul_f32 v204, s26, v204
    v_mul_f32 v205, s26, v205
    s_waitcnt lgkmcnt(0)
    v_mfma_f32_32x32x16_bf16 v[208:223], v[156:159], v[60:63], v[208:223]
    v_cvt_pk_bf16_f32 v86, v204, v205
    v_mul_f32 v206, s26, v206
    v_mul_f32 v207, s26, v207
    v_cvt_pk_bf16_f32 v87, v206, v207
    s_waitcnt vmcnt(0)
    s_barrier
    v_lshrrev_b32 v17, 4, v3
    v_lshlrev_b32 v17, 12, v17
    v_and_b32 v18, 15, v3
    v_lshl_add_u32 v17, v18, 4, v17
    v_lshl_add_u32 v17, v4, 8, v17
    s_add_u32 s28, s21, 0
    s_add_u32 s29, s21, 4194304
    ds_read_b64_tr_b16 v[96:97], v8 offset:32768
    ds_read_b64_tr_b16 v[98:99], v8 offset:33792
    ds_read_b64_tr_b16 v[100:101], v8 offset:36864
    ds_read_b64_tr_b16 v[102:103], v8 offset:37888
    ds_read_b64_tr_b16 v[104:105], v8 offset:40960
    ds_read_b64_tr_b16 v[106:107], v8 offset:41984
    ds_read_b64_tr_b16 v[108:109], v8 offset:45056
    ds_read_b64_tr_b16 v[110:111], v8 offset:46080
    ds_read_b64_tr_b16 v[112:113], v8 offset:49152
    ds_read_b64_tr_b16 v[114:115], v8 offset:50176
    ds_read_b64_tr_b16 v[116:117], v8 offset:53248
    ds_read_b64_tr_b16 v[118:119], v8 offset:54272
    ds_read_b64_tr_b16 v[120:121], v8 offset:57344
    ds_read_b64_tr_b16 v[122:123], v8 offset:58368
    ds_read_b64_tr_b16 v[124:125], v8 offset:61440
    ds_read_b64_tr_b16 v[126:127], v8 offset:62464
    buffer_store_dwordx4 v[64:67], v17, s[16:19], s28 offen offset:0 sc1
    buffer_store_dwordx4 v[68:71], v17, s[16:19], s28 offen offset:512 sc1
    buffer_store_dwordx4 v[72:75], v17, s[16:19], s28 offen offset:1024 sc1
    buffer_store_dwordx4 v[76:79], v17, s[16:19], s28 offen offset:1536 sc1
    buffer_store_dwordx4 v[80:83], v17, s[16:19], s28 offen offset:2048 sc1
    buffer_store_dwordx4 v[84:87], v17, s[16:19], s28 offen offset:2560 sc1
    v_mul_f32 v208, s26, v208
    v_mul_f32 v209, s26, v209
    v_cvt_pk_bf16_f32 v88, v208, v209
    v_mul_f32 v210, s26, v210
    v_mul_f32 v211, s26, v211
    v_cvt_pk_bf16_f32 v89, v210, v211
    v_mul_f32 v212, s26, v212
    v_mul_f32 v213, s26, v213
    v_cvt_pk_bf16_f32 v90, v212, v213
    v_mul_f32 v214, s26, v214
    v_mul_f32 v215, s26, v215
    v_cvt_pk_bf16_f32 v91, v214, v215
    v_mul_f32 v216, s26, v216
    v_mul_f32 v217, s26, v217
    v_cvt_pk_bf16_f32 v92, v216, v217
    v_mul_f32 v218, s26, v218
    v_mul_f32 v219, s26, v219
    v_cvt_pk_bf16_f32 v93, v218, v219
    v_mul_f32 v220, s26, v220
    v_mul_f32 v221, s26, v221
    v_cvt_pk_bf16_f32 v94, v220, v221
    v_mul_f32 v222, s26, v222
    v_mul_f32 v223, s26, v223
    v_cvt_pk_bf16_f32 v95, v222, v223
    buffer_store_dwordx4 v[88:91], v17, s[16:19], s28 offen offset:3072 sc1
    buffer_store_dwordx4 v[92:95], v17, s[16:19], s28 offen offset:3584 sc1
    s_waitcnt lgkmcnt(14)
    v_mfma_f32_32x32x16_bf16 v[160:175], v[96:99], v[32:35], 0
    ds_read_b64_tr_b16 v[128:129], v9 offset:32768
    ds_read_b64_tr_b16 v[130:131], v9 offset:33792
    s_waitcnt lgkmcnt(14)
    v_mfma_f32_32x32x16_bf16 v[160:175], v[100:103], v[36:39], v[160:175]
    ds_read_b64_tr_b16 v[132:133], v9 offset:36864
    ds_read_b64_tr_b16 v[134:135], v9 offset:37888
    s_waitcnt lgkmcnt(14)
    v_mfma_f32_32x32x16_bf16 v[160:175], v[104:107], v[40:43], v[160:175]
    ds_read_b64_tr_b16 v[136:137], v9 offset:40960
    ds_read_b64_tr_b16 v[138:139], v9 offset:41984
    s_waitcnt lgkmcnt(14)
    v_mfma_f32_32x32x16_bf16 v[160:175], v[108:111], v[44:47], v[160:175]
    ds_read_b64_tr_b16 v[140:141], v9 offset:45056
    ds_read_b64_tr_b16 v[142:143], v9 offset:46080
    s_waitcnt lgkmcnt(14)
    v_mfma_f32_32x32x16_bf16 v[160:175], v[112:115], v[48:51], v[160:175]
    ds_read_b64_tr_b16 v[144:145], v9 offset:49152
    ds_read_b64_tr_b16 v[146:147], v9 offset:50176
    s_waitcnt lgkmcnt(14)
    v_mfma_f32_32x32x16_bf16 v[160:175], v[116:119], v[52:55], v[160:175]
    ds_read_b64_tr_b16 v[148:149], v9 offset:53248
    ds_read_b64_tr_b16 v[150:151], v9 offset:54272
    s_waitcnt lgkmcnt(14)
    v_mfma_f32_32x32x16_bf16 v[160:175], v[120:123], v[56:59], v[160:175]
    ds_read_b64_tr_b16 v[152:153], v9 offset:57344
    ds_read_b64_tr_b16 v[154:155], v9 offset:58368
    s_waitcnt lgkmcnt(14)
    v_mfma_f32_32x32x16_bf16 v[160:175], v[124:127], v[60:63], v[160:175]
    ds_read_b64_tr_b16 v[156:157], v9 offset:61440
    ds_read_b64_tr_b16 v[158:159], v9 offset:62464
    s_waitcnt lgkmcnt(14)
    v_mfma_f32_32x32x16_bf16 v[176:191], v[128:131], v[32:35], 0
    ds_read_b64_tr_b16 v[96:97], v10 offset:32768
    ds_read_b64_tr_b16 v[98:99], v10 offset:33792
    s_waitcnt lgkmcnt(14)
    v_mfma_f32_32x32x16_bf16 v[176:191], v[132:135], v[36:39], v[176:191]
    ds_read_b64_tr_b16 v[100:101], v10 offset:36864
    ds_read_b64_tr_b16 v[102:103], v10 offset:37888
    s_waitcnt lgkmcnt(14)
    v_mfma_f32_32x32x16_bf16 v[176:191], v[136:139], v[40:43], v[176:191]
    ds_read_b64_tr_b16 v[104:105], v10 offset:40960
    ds_read_b64_tr_b16 v[106:107], v10 offset:41984
    v_cvt_pk_bf16_f32 v64, v160, v161
    v_cvt_pk_bf16_f32 v65, v162, v163
    s_waitcnt lgkmcnt(14)
    v_mfma_f32_32x32x16_bf16 v[176:191], v[140:143], v[44:47], v[176:191]
    ds_read_b64_tr_b16 v[108:109], v10 offset:45056
    ds_read_b64_tr_b16 v[110:111], v10 offset:46080
    v_cvt_pk_bf16_f32 v66, v164, v165
    v_cvt_pk_bf16_f32 v67, v166, v167
    s_waitcnt lgkmcnt(14)
    v_mfma_f32_32x32x16_bf16 v[176:191], v[144:147], v[48:51], v[176:191]
    ds_read_b64_tr_b16 v[112:113], v10 offset:49152
    ds_read_b64_tr_b16 v[114:115], v10 offset:50176
    v_cvt_pk_bf16_f32 v68, v168, v169
    v_cvt_pk_bf16_f32 v69, v170, v171
    s_waitcnt lgkmcnt(14)
    v_mfma_f32_32x32x16_bf16 v[176:191], v[148:151], v[52:55], v[176:191]
    ds_read_b64_tr_b16 v[116:117], v10 offset:53248
    ds_read_b64_tr_b16 v[118:119], v10 offset:54272
    v_cvt_pk_bf16_f32 v70, v172, v173
    v_cvt_pk_bf16_f32 v71, v174, v175
    s_waitcnt lgkmcnt(14)
    v_mfma_f32_32x32x16_bf16 v[176:191], v[152:155], v[56:59], v[176:191]
    ds_read_b64_tr_b16 v[120:121], v10 offset:57344
    ds_read_b64_tr_b16 v[122:123], v10 offset:58368
    buffer_store_dwordx4 v[64:67], v17, s[16:19], s29 offen offset:0 sc1
    buffer_store_dwordx4 v[68:71], v17, s[16:19], s29 offen offset:512 sc1
    s_waitcnt lgkmcnt(14)
    v_mfma_f32_32x32x16_bf16 v[176:191], v[156:159], v[60:63], v[176:191]
    ds_read_b64_tr_b16 v[124:125], v10 offset:61440
    ds_read_b64_tr_b16 v[126:127], v10 offset:62464
    s_waitcnt lgkmcnt(14)
    v_mfma_f32_32x32x16_bf16 v[192:207], v[96:99], v[32:35], 0
    ds_read_b64_tr_b16 v[128:129], v11 offset:32768
    ds_read_b64_tr_b16 v[130:131], v11 offset:33792
    s_waitcnt lgkmcnt(14)
    v_mfma_f32_32x32x16_bf16 v[192:207], v[100:103], v[36:39], v[192:207]
    ds_read_b64_tr_b16 v[132:133], v11 offset:36864
    ds_read_b64_tr_b16 v[134:135], v11 offset:37888
    s_waitcnt lgkmcnt(14)
    v_mfma_f32_32x32x16_bf16 v[192:207], v[104:107], v[40:43], v[192:207]
    ds_read_b64_tr_b16 v[136:137], v11 offset:40960
    ds_read_b64_tr_b16 v[138:139], v11 offset:41984
    v_cvt_pk_bf16_f32 v72, v176, v177
    v_cvt_pk_bf16_f32 v73, v178, v179
    s_waitcnt lgkmcnt(14)
    v_mfma_f32_32x32x16_bf16 v[192:207], v[108:111], v[44:47], v[192:207]
    ds_read_b64_tr_b16 v[140:141], v11 offset:45056
    ds_read_b64_tr_b16 v[142:143], v11 offset:46080
    v_cvt_pk_bf16_f32 v74, v180, v181
    v_cvt_pk_bf16_f32 v75, v182, v183
    s_waitcnt lgkmcnt(14)
    v_mfma_f32_32x32x16_bf16 v[192:207], v[112:115], v[48:51], v[192:207]
    ds_read_b64_tr_b16 v[144:145], v11 offset:49152
    ds_read_b64_tr_b16 v[146:147], v11 offset:50176
    v_cvt_pk_bf16_f32 v76, v184, v185
    v_cvt_pk_bf16_f32 v77, v186, v187
    s_waitcnt lgkmcnt(14)
    v_mfma_f32_32x32x16_bf16 v[192:207], v[116:119], v[52:55], v[192:207]
    ds_read_b64_tr_b16 v[148:149], v11 offset:53248
    ds_read_b64_tr_b16 v[150:151], v11 offset:54272
    v_cvt_pk_bf16_f32 v78, v188, v189
    v_cvt_pk_bf16_f32 v79, v190, v191
    s_waitcnt lgkmcnt(14)
    v_mfma_f32_32x32x16_bf16 v[192:207], v[120:123], v[56:59], v[192:207]
    ds_read_b64_tr_b16 v[152:153], v11 offset:57344
    ds_read_b64_tr_b16 v[154:155], v11 offset:58368
    buffer_store_dwordx4 v[72:75], v17, s[16:19], s29 offen offset:1024 sc1
    buffer_store_dwordx4 v[76:79], v17, s[16:19], s29 offen offset:1536 sc1
    s_waitcnt lgkmcnt(14)
    v_mfma_f32_32x32x16_bf16 v[192:207], v[124:127], v[60:63], v[192:207]
    ds_read_b64_tr_b16 v[156:157], v11 offset:61440
    ds_read_b64_tr_b16 v[158:159], v11 offset:62464
    s_waitcnt lgkmcnt(14)
    v_mfma_f32_32x32x16_bf16 v[208:223], v[128:131], v[32:35], 0
    s_waitcnt lgkmcnt(12)
    v_mfma_f32_32x32x16_bf16 v[208:223], v[132:135], v[36:39], v[208:223]
    s_waitcnt lgkmcnt(10)
    v_mfma_f32_32x32x16_bf16 v[208:223], v[136:139], v[40:43], v[208:223]
    v_cvt_pk_bf16_f32 v80, v192, v193
    v_cvt_pk_bf16_f32 v81, v194, v195
    s_waitcnt lgkmcnt(8)
    v_mfma_f32_32x32x16_bf16 v[208:223], v[140:143], v[44:47], v[208:223]
    v_cvt_pk_bf16_f32 v82, v196, v197
    v_cvt_pk_bf16_f32 v83, v198, v199
    s_waitcnt lgkmcnt(6)
    v_mfma_f32_32x32x16_bf16 v[208:223], v[144:147], v[48:51], v[208:223]
    v_cvt_pk_bf16_f32 v84, v200, v201
    v_cvt_pk_bf16_f32 v85, v202, v203
    s_waitcnt lgkmcnt(4)
    v_mfma_f32_32x32x16_bf16 v[208:223], v[148:151], v[52:55], v[208:223]
    v_cvt_pk_bf16_f32 v86, v204, v205
    v_cvt_pk_bf16_f32 v87, v206, v207
    s_waitcnt lgkmcnt(2)
    v_mfma_f32_32x32x16_bf16 v[208:223], v[152:155], v[56:59], v[208:223]
    buffer_store_dwordx4 v[80:83], v17, s[16:19], s29 offen offset:2048 sc1
    buffer_store_dwordx4 v[84:87], v17, s[16:19], s29 offen offset:2560 sc1
    s_waitcnt lgkmcnt(0)
    v_mfma_f32_32x32x16_bf16 v[208:223], v[156:159], v[60:63], v[208:223]
    s_nop 7
    s_nop 3
    v_cvt_pk_bf16_f32 v88, v208, v209
    v_cvt_pk_bf16_f32 v89, v210, v211
    v_cvt_pk_bf16_f32 v90, v212, v213
    v_cvt_pk_bf16_f32 v91, v214, v215
    v_cvt_pk_bf16_f32 v92, v216, v217
    v_cvt_pk_bf16_f32 v93, v218, v219
    v_cvt_pk_bf16_f32 v94, v220, v221
    v_cvt_pk_bf16_f32 v95, v222, v223
    buffer_store_dwordx4 v[88:91], v17, s[16:19], s29 offen offset:3072 sc1
    buffer_store_dwordx4 v[92:95], v17, s[16:19], s29 offen offset:3584 sc1
    s_branch L_k1_end
L_k1_second:
    s_waitcnt vmcnt(8)
    s_barrier
    ds_read_b64_tr_b16 v[96:97], v12 offset:32768
    ds_read_b64_tr_b16 v[98:99], v12 offset:34816
    ds_read_b64_tr_b16 v[100:101], v12 offset:36864
    ds_read_b64_tr_b16 v[102:103], v12 offset:38912
    ds_read_b64_tr_b16 v[104:105], v12 offset:40960
    ds_read_b64_tr_b16 v[106:107], v12 offset:43008
    ds_read_b64_tr_b16 v[108:109], v12 offset:45056
    ds_read_b64_tr_b16 v[110:111], v12 offset:47104
    ds_read_b64_tr_b16 v[112:113], v12 offset:49152
    ds_read_b64_tr_b16 v[114:115], v12 offset:51200
    ds_read_b64_tr_b16 v[116:117], v12 offset:53248
    ds_read_b64_tr_b16 v[118:119], v12 offset:55296
    ds_read_b64_tr_b16 v[120:121], v12 offset:57344
    ds_read_b64_tr_b16 v[122:123], v12 offset:59392
    ds_read_b64_tr_b16 v[124:125], v12 offset:61440
    ds_read_b64_tr_b16 v[126:127], v12 offset:63488
    v_cvt_pk_bf16_f32 v88, v208, v209
    v_cvt_pk_bf16_f32 v89, v210, v211
    v_cvt_pk_bf16_f32 v90, v212, v213
    v_cvt_pk_bf16_f32 v91, v214, v215
    v_cvt_pk_bf16_f32 v92, v216, v217
    v_cvt_pk_bf16_f32 v93, v218, v219
    v_cvt_pk_bf16_f32 v94, v220, v221
    v_cvt_pk_bf16_f32 v95, v222, v223
    v_lshrrev_b32 v17, 4, v3
    v_lshlrev_b32 v17, 10, v17
    v_and_b32 v18, 15, v3
    v_lshl_add_u32 v17, v18, 4, v17
    v_lshl_add_u32 v17, v4, 8, v17
    s_add_u32 s28, s21, 8388608
    s_add_u32 s29, s28, 4096
    s_waitcnt lgkmcnt(14)
    v_mfma_f32_32x32x16_bf16 v[160:175], v[64:67], v[96:99], 0
    ds_read_b64_tr_b16 v[128:129], v13 offset:32768
    ds_read_b64_tr_b16 v[130:131], v13 offset:34816
    s_waitcnt lgkmcnt(14)
    v_mfma_f32_32x32x16_bf16 v[160:175], v[68:71], v[100:103], v[160:175]
    ds_read_b64_tr_b16 v[132:133], v13 offset:36864
    ds_read_b64_tr_b16 v[134:135], v13 offset:38912
    s_waitcnt lgkmcnt(14)
    v_mfma_f32_32x32x16_bf16 v[160:175], v[72:75], v[104:107], v[160:175]
    ds_read_b64_tr_b16 v[136:137], v13 offset:40960
    ds_read_b64_tr_b16 v[138:139], v13 offset:43008
    s_waitcnt lgkmcnt(14)
    v_mfma_f32_32x32x16_bf16 v[160:175], v[76:79], v[108:111], v[160:175]
    ds_read_b64_tr_b16 v[140:141], v13 offset:45056
    ds_read_b64_tr_b16 v[142:143], v13 offset:47104
    s_waitcnt lgkmcnt(14)
    v_mfma_f32_32x32x16_bf16 v[160:175], v[80:83], v[112:115], v[160:175]
    ds_read_b64_tr_b16 v[144:145], v13 offset:49152
    ds_read_b64_tr_b16 v[146:147], v13 offset:51200
    s_waitcnt lgkmcnt(14)
    v_mfma_f32_32x32x16_bf16 v[160:175], v[84:87], v[116:119], v[160:175]
    ds_read_b64_tr_b16 v[148:149], v13 offset:53248
    ds_read_b64_tr_b16 v[150:151], v13 offset:55296
    s_waitcnt lgkmcnt(14)
    v_mfma_f32_32x32x16_bf16 v[160:175], v[88:91], v[120:123], v[160:175]
    ds_read_b64_tr_b16 v[152:153], v13 offset:57344
    ds_read_b64_tr_b16 v[154:155], v13 offset:59392
    s_waitcnt lgkmcnt(14)
    v_mfma_f32_32x32x16_bf16 v[160:175], v[92:95], v[124:127], v[160:175]
    ds_read_b64_tr_b16 v[156:157], v13 offset:61440
    ds_read_b64_tr_b16 v[158:159], v13 offset:63488
    s_waitcnt lgkmcnt(14)
    v_mfma_f32_32x32x16_bf16 v[176:191], v[64:67], v[128:131], 0
    ds_read_b64_tr_b16 v[96:97], v14 offset:32768
    ds_read_b64_tr_b16 v[98:99], v14 offset:34816
    s_waitcnt lgkmcnt(14)
    v_mfma_f32_32x32x16_bf16 v[176:191], v[68:71], v[132:135], v[176:191]
    ds_read_b64_tr_b16 v[100:101], v14 offset:36864
    ds_read_b64_tr_b16 v[102:103], v14 offset:38912
    s_waitcnt lgkmcnt(14)
    v_mfma_f32_32x32x16_bf16 v[176:191], v[72:75], v[136:139], v[176:191]
    ds_read_b64_tr_b16 v[104:105], v14 offset:40960
    ds_read_b64_tr_b16 v[106:107], v14 offset:43008
    v_cvt_pk_bf16_f32 v32, v160, v161
    v_cvt_pk_bf16_f32 v33, v162, v163
    s_waitcnt lgkmcnt(14)
    v_mfma_f32_32x32x16_bf16 v[176:191], v[76:79], v[140:143], v[176:191]
    ds_read_b64_tr_b16 v[108:109], v14 offset:45056
    ds_read_b64_tr_b16 v[110:111], v14 offset:47104
    v_cvt_pk_bf16_f32 v34, v168, v169
    v_cvt_pk_bf16_f32 v35, v170, v171
    s_waitcnt lgkmcnt(14)
    v_mfma_f32_32x32x16_bf16 v[176:191], v[80:83], v[144:147], v[176:191]
    ds_read_b64_tr_b16 v[112:113], v14 offset:49152
    ds_read_b64_tr_b16 v[114:115], v14 offset:51200
    buffer_store_dwordx4 v[32:35], v17, s[16:19], s28 offen offset:0 sc1
    v_cvt_pk_bf16_f32 v36, v164, v165
    s_waitcnt lgkmcnt(14)
    v_mfma_f32_32x32x16_bf16 v[176:191], v[84:87], v[148:151], v[176:191]
    ds_read_b64_tr_b16 v[116:117], v14 offset:53248
    ds_read_b64_tr_b16 v[118:119], v14 offset:55296
    v_cvt_pk_bf16_f32 v37, v166, v167
    v_cvt_pk_bf16_f32 v38, v172, v173
    s_waitcnt lgkmcnt(14)
    v_mfma_f32_32x32x16_bf16 v[176:191], v[88:91], v[152:155], v[176:191]
    ds_read_b64_tr_b16 v[120:121], v14 offset:57344
    ds_read_b64_tr_b16 v[122:123], v14 offset:59392
    v_cvt_pk_bf16_f32 v39, v174, v175
    buffer_store_dwordx4 v[36:39], v17, s[16:19], s28 offen offset:512 sc1
    s_waitcnt lgkmcnt(14)
    v_mfma_f32_32x32x16_bf16 v[176:191], v[92:95], v[156:159], v[176:191]
    ds_read_b64_tr_b16 v[124:125], v14 offset:61440
    ds_read_b64_tr_b16 v[126:127], v14 offset:63488
    s_waitcnt lgkmcnt(14)
    v_mfma_f32_32x32x16_bf16 v[192:207], v[64:67], v[96:99], 0
    ds_read_b64_tr_b16 v[128:129], v15 offset:32768
    ds_read_b64_tr_b16 v[130:131], v15 offset:34816
    s_waitcnt lgkmcnt(14)
    v_mfma_f32_32x32x16_bf16 v[192:207], v[68:71], v[100:103], v[192:207]
    ds_read_b64_tr_b16 v[132:133], v15 offset:36864
    ds_read_b64_tr_b16 v[134:135], v15 offset:38912
    s_waitcnt lgkmcnt(14)
    v_mfma_f32_32x32x16_bf16 v[192:207], v[72:75], v[104:107], v[192:207]
    ds_read_b64_tr_b16 v[136:137], v15 offset:40960
    ds_read_b64_tr_b16 v[138:139], v15 offset:43008
    v_cvt_pk_bf16_f32 v40, v176, v177
    v_cvt_pk_bf16_f32 v41, v178, v179
    s_waitcnt lgkmcnt(14)
    v_mfma_f32_32x32x16_bf16 v[192:207], v[76:79], v[108:111], v[192:207]
    ds_read_b64_tr_b16 v[140:141], v15 offset:45056
    ds_read_b64_tr_b16 v[142:143], v15 offset:47104
    v_cvt_pk_bf16_f32 v42, v184, v185
    v_cvt_pk_bf16_f32 v43, v186, v187
    s_waitcnt lgkmcnt(14)
    v_mfma_f32_32x32x16_bf16 v[192:207], v[80:83], v[112:115], v[192:207]
    ds_read_b64_tr_b16 v[144:145], v15 offset:49152
    ds_read_b64_tr_b16 v[146:147], v15 offset:51200
    buffer_store_dwordx4 v[40:43], v17, s[16:19], s28 offen offset:2048 sc1
    v_cvt_pk_bf16_f32 v44, v180, v181
    s_waitcnt lgkmcnt(14)
    v_mfma_f32_32x32x16_bf16 v[192:207], v[84:87], v[116:119], v[192:207]
    ds_read_b64_tr_b16 v[148:149], v15 offset:53248
    ds_read_b64_tr_b16 v[150:151], v15 offset:55296
    v_cvt_pk_bf16_f32 v45, v182, v183
    v_cvt_pk_bf16_f32 v46, v188, v189
    s_waitcnt lgkmcnt(14)
    v_mfma_f32_32x32x16_bf16 v[192:207], v[88:91], v[120:123], v[192:207]
    ds_read_b64_tr_b16 v[152:153], v15 offset:57344
    ds_read_b64_tr_b16 v[154:155], v15 offset:59392
    v_cvt_pk_bf16_f32 v47, v190, v191
    buffer_store_dwordx4 v[44:47], v17, s[16:19], s28 offen offset:2560 sc1
    s_waitcnt lgkmcnt(14)
    v_mfma_f32_32x32x16_bf16 v[192:207], v[92:95], v[124:127], v[192:207]
    ds_read_b64_tr_b16 v[156:157], v15 offset:61440
    ds_read_b64_tr_b16 v[158:159], v15 offset:63488
    s_waitcnt lgkmcnt(14)
    v_mfma_f32_32x32x16_bf16 v[208:223], v[64:67], v[128:131], 0
    s_waitcnt lgkmcnt(12)
    v_mfma_f32_32x32x16_bf16 v[208:223], v[68:71], v[132:135], v[208:223]
    s_waitcnt lgkmcnt(10)
    v_mfma_f32_32x32x16_bf16 v[208:223], v[72:75], v[136:139], v[208:223]
    v_cvt_pk_bf16_f32 v48, v192, v193
    v_cvt_pk_bf16_f32 v49, v194, v195
    s_waitcnt lgkmcnt(8)
    v_mfma_f32_32x32x16_bf16 v[208:223], v[76:79], v[140:143], v[208:223]
    v_cvt_pk_bf16_f32 v50, v200, v201
    v_cvt_pk_bf16_f32 v51, v202, v203
    s_waitcnt lgkmcnt(6)
    v_mfma_f32_32x32x16_bf16 v[208:223], v[80:83], v[144:147], v[208:223]
    buffer_store_dwordx4 v[48:51], v17, s[16:19], s29 offen offset:0 sc1
    v_cvt_pk_bf16_f32 v52, v196, v197
    s_waitcnt lgkmcnt(4)
    v_mfma_f32_32x32x16_bf16 v[208:223], v[84:87], v[148:151], v[208:223]
    v_cvt_pk_bf16_f32 v53, v198, v199
    v_cvt_pk_bf16_f32 v54, v204, v205
    s_waitcnt lgkmcnt(2)
    v_mfma_f32_32x32x16_bf16 v[208:223], v[88:91], v[152:155], v[208:223]
    v_cvt_pk_bf16_f32 v55, v206, v207
    buffer_store_dwordx4 v[52:55], v17, s[16:19], s29 offen offset:512 sc1
    s_waitcnt lgkmcnt(0)
    v_mfma_f32_32x32x16_bf16 v[208:223], v[92:95], v[156:159], v[208:223]
    s_nop 7
    s_nop 3
    v_cvt_pk_bf16_f32 v56, v208, v209
    v_cvt_pk_bf16_f32 v57, v210, v211
    v_cvt_pk_bf16_f32 v58, v216, v217
    v_cvt_pk_bf16_f32 v59, v218, v219
    buffer_store_dwordx4 v[56:59], v17, s[16:19], s29 offen offset:2048 sc1
    v_cvt_pk_bf16_f32 v60, v212, v213
    v_cvt_pk_bf16_f32 v61, v214, v215
    v_cvt_pk_bf16_f32 v62, v220, v221
    v_cvt_pk_bf16_f32 v63, v222, v223
    buffer_store_dwordx4 v[60:63], v17, s[16:19], s29 offen offset:2560 sc1
    s_branch L_k1_end
L_k1_w:
    v_lshrrev_b32 v17, 4, v3
    v_lshlrev_b32 v17, 12, v17
    v_and_b32 v18, 15, v3
    v_lshl_add_u32 v17, v18, 4, v17
    v_lshl_add_u32 v17, v4, 8, v17
    s_lshl_b32 s28, s22, 10
    s_add_u32 s28, s28, 15728640
    s_waitcnt vmcnt(0) lgkmcnt(0)
    s_barrier
    ds_read_b64_tr_b16 v[96:97], v8 offset:0
    ds_read_b64_tr_b16 v[98:99], v8 offset:1024
    ds_read_b64_tr_b16 v[100:101], v8 offset:4096
    ds_read_b64_tr_b16 v[102:103], v8 offset:5120
    ds_read_b64_tr_b16 v[104:105], v8 offset:8192
    ds_read_b64_tr_b16 v[106:107], v8 offset:9216
    ds_read_b64_tr_b16 v[108:109], v8 offset:12288
    ds_read_b64_tr_b16 v[110:111], v8 offset:13312
    ds_read_b64_tr_b16 v[112:113], v8 offset:16384
    ds_read_b64_tr_b16 v[114:115], v8 offset:17408
    ds_read_b64_tr_b16 v[116:117], v8 offset:20480
    ds_read_b64_tr_b16 v[118:119], v8 offset:21504
    ds_read_b64_tr_b16 v[120:121], v8 offset:24576
    ds_read_b64_tr_b16 v[122:123], v8 offset:25600
    ds_read_b64_tr_b16 v[124:125], v8 offset:28672
    ds_read_b64_tr_b16 v[126:127], v8 offset:29696
    s_waitcnt lgkmcnt(14)
    v_mfma_f32_32x32x16_bf16 v[160:175], v[64:67], v[96:99], 0
    ds_read_b64_tr_b16 v[128:129], v9 offset:0
    ds_read_b64_tr_b16 v[130:131], v9 offset:1024
    s_waitcnt lgkmcnt(14)
    v_mfma_f32_32x32x16_bf16 v[160:175], v[68:71], v[100:103], v[160:175]
    ds_read_b64_tr_b16 v[132:133], v9 offset:4096
    ds_read_b64_tr_b16 v[134:135], v9 offset:5120
    s_waitcnt lgkmcnt(14)
    v_mfma_f32_32x32x16_bf16 v[160:175], v[72:75], v[104:107], v[160:175]
    ds_read_b64_tr_b16 v[136:137], v9 offset:8192
    ds_read_b64_tr_b16 v[138:139], v9 offset:9216
    s_waitcnt lgkmcnt(14)
    v_mfma_f32_32x32x16_bf16 v[160:175], v[76:79], v[108:111], v[160:175]
    ds_read_b64_tr_b16 v[140:141], v9 offset:12288
    ds_read_b64_tr_b16 v[142:143], v9 offset:13312
    s_waitcnt lgkmcnt(14)
    v_mfma_f32_32x32x16_bf16 v[160:175], v[80:83], v[112:115], v[160:175]
    ds_read_b64_tr_b16 v[144:145], v9 offset:16384
    ds_read_b64_tr_b16 v[146:147], v9 offset:17408
    s_waitcnt lgkmcnt(14)
    v_mfma_f32_32x32x16_bf16 v[160:175], v[84:87], v[116:119], v[160:175]
    ds_read_b64_tr_b16 v[148:149], v9 offset:20480
    ds_read_b64_tr_b16 v[150:151], v9 offset:21504
    s_waitcnt lgkmcnt(14)
    v_mfma_f32_32x32x16_bf16 v[160:175], v[88:91], v[120:123], v[160:175]
    ds_read_b64_tr_b16 v[152:153], v9 offset:24576
    ds_read_b64_tr_b16 v[154:155], v9 offset:25600
    s_waitcnt lgkmcnt(14)
    v_mfma_f32_32x32x16_bf16 v[160:175], v[92:95], v[124:127], v[160:175]
    ds_read_b64_tr_b16 v[156:157], v9 offset:28672
    ds_read_b64_tr_b16 v[158:159], v9 offset:29696
    s_waitcnt lgkmcnt(14)
    v_mfma_f32_32x32x16_bf16 v[176:191], v[64:67], v[128:131], 0
    ds_read_b64_tr_b16 v[96:97], v10 offset:0
    ds_read_b64_tr_b16 v[98:99], v10 offset:1024
    s_waitcnt lgkmcnt(14)
    v_mfma_f32_32x32x16_bf16 v[176:191], v[68:71], v[132:135], v[176:191]
    ds_read_b64_tr_b16 v[100:101], v10 offset:4096
    ds_read_b64_tr_b16 v[102:103], v10 offset:5120
    s_waitcnt lgkmcnt(14)
    v_mfma_f32_32x32x16_bf16 v[176:191], v[72:75], v[136:139], v[176:191]
    ds_read_b64_tr_b16 v[104:105], v10 offset:8192
    ds_read_b64_tr_b16 v[106:107], v10 offset:9216
    s_waitcnt lgkmcnt(14)
    v_mfma_f32_32x32x16_bf16 v[176:191], v[76:79], v[140:143], v[176:191]
    ds_read_b64_tr_b16 v[108:109], v10 offset:12288
    ds_read_b64_tr_b16 v[110:111], v10 offset:13312
    s_waitcnt lgkmcnt(14)
    v_mfma_f32_32x32x16_bf16 v[176:191], v[80:83], v[144:147], v[176:191]
    ds_read_b64_tr_b16 v[112:113], v10 offset:16384
    ds_read_b64_tr_b16 v[114:115], v10 offset:17408
    s_waitcnt lgkmcnt(14)
    v_mfma_f32_32x32x16_bf16 v[176:191], v[84:87], v[148:151], v[176:191]
    ds_read_b64_tr_b16 v[116:117], v10 offset:20480
    ds_read_b64_tr_b16 v[118:119], v10 offset:21504
    s_waitcnt lgkmcnt(14)
    v_mfma_f32_32x32x16_bf16 v[176:191], v[88:91], v[152:155], v[176:191]
    ds_read_b64_tr_b16 v[120:121], v10 offset:24576
    ds_read_b64_tr_b16 v[122:123], v10 offset:25600
    s_waitcnt lgkmcnt(14)
    v_mfma_f32_32x32x16_bf16 v[176:191], v[92:95], v[156:159], v[176:191]
    ds_read_b64_tr_b16 v[124:125], v10 offset:28672
    ds_read_b64_tr_b16 v[126:127], v10 offset:29696
    s_waitcnt lgkmcnt(14)
    v_mfma_f32_32x32x16_bf16 v[192:207], v[64:67], v[96:99], 0
    ds_read_b64_tr_b16 v[128:129], v11 offset:0
    ds_read_b64_tr_b16 v[130:131], v11 offset:1024
    s_waitcnt lgkmcnt(14)
    v_mfma_f32_32x32x16_bf16 v[192:207], v[68:71], v[100:103], v[192:207]
    ds_read_b64_tr_b16 v[132:133], v11 offset:4096
    ds_read_b64_tr_b16 v[134:135], v11 offset:5120
    s_waitcnt lgkmcnt(14)
    v_mfma_f32_32x32x16_bf16 v[192:207], v[72:75], v[104:107], v[192:207]
    ds_read_b64_tr_b16 v[136:137], v11 offset:8192
    ds_read_b64_tr_b16 v[138:139], v11 offset:9216
    s_waitcnt lgkmcnt(14)
    v_mfma_f32_32x32x16_bf16 v[192:207], v[76:79], v[108:111], v[192:207]
    ds_read_b64_tr_b16 v[140:141], v11 offset:12288
    ds_read_b64_tr_b16 v[142:143], v11 offset:13312
    s_waitcnt lgkmcnt(14)
    v_mfma_f32_32x32x16_bf16 v[192:207], v[80:83], v[112:115], v[192:207]
    ds_read_b64_tr_b16 v[144:145], v11 offset:16384
    ds_read_b64_tr_b16 v[146:147], v11 offset:17408
    s_waitcnt lgkmcnt(14)
    v_mfma_f32_32x32x16_bf16 v[192:207], v[84:87], v[116:119], v[192:207]
    ds_read_b64_tr_b16 v[148:149], v11 offset:20480
    ds_read_b64_tr_b16 v[150:151], v11 offset:21504
    s_waitcnt lgkmcnt(14)
    v_mfma_f32_32x32x16_bf16 v[192:207], v[88:91], v[120:123], v[192:207]
    ds_read_b64_tr_b16 v[152:153], v11 offset:24576
    ds_read_b64_tr_b16 v[154:155], v11 offset:25600
    s_waitcnt lgkmcnt(14)
    v_mfma_f32_32x32x16_bf16 v[192:207], v[92:95], v[124:127], v[192:207]
    ds_read_b64_tr_b16 v[156:157], v11 offset:28672
    ds_read_b64_tr_b16 v[158:159], v11 offset:29696
    s_waitcnt lgkmcnt(14)
    v_mfma_f32_32x32x16_bf16 v[208:223], v[64:67], v[128:131], 0
    s_waitcnt lgkmcnt(12)
    v_mfma_f32_32x32x16_bf16 v[208:223], v[68:71], v[132:135], v[208:223]
    s_waitcnt lgkmcnt(10)
    v_mfma_f32_32x32x16_bf16 v[208:223], v[72:75], v[136:139], v[208:223]
    s_waitcnt lgkmcnt(8)
    v_mfma_f32_32x32x16_bf16 v[208:223], v[76:79], v[140:143], v[208:223]
    s_waitcnt lgkmcnt(6)
    v_mfma_f32_32x32x16_bf16 v[208:223], v[80:83], v[144:147], v[208:223]
    s_waitcnt lgkmcnt(4)
    v_mfma_f32_32x32x16_bf16 v[208:223], v[84:87], v[148:151], v[208:223]
    s_waitcnt lgkmcnt(2)
    v_mfma_f32_32x32x16_bf16 v[208:223], v[88:91], v[152:155], v[208:223]
    s_waitcnt lgkmcnt(0)
    v_mfma_f32_32x32x16_bf16 v[208:223], v[92:95], v[156:159], v[208:223]
    s_nop 7
    s_nop 3
    v_cvt_pk_bf16_f32 v32, v160, v161
    v_cvt_pk_bf16_f32 v33, v162, v163
    v_cvt_pk_bf16_f32 v34, v164, v165
    v_cvt_pk_bf16_f32 v35, v166, v167
    buffer_store_dwordx4 v[32:35], v17, s[16:19], s28 offen offset:0 sc1
    v_cvt_pk_bf16_f32 v36, v168, v169
    v_cvt_pk_bf16_f32 v37, v170, v171
    v_cvt_pk_bf16_f32 v38, v172, v173
    v_cvt_pk_bf16_f32 v39, v174, v175
    buffer_store_dwordx4 v[36:39], v17, s[16:19], s28 offen offset:512 sc1
    s_add_u32 s28, s28, 8192
    v_cvt_pk_bf16_f32 v40, v176, v177
    v_cvt_pk_bf16_f32 v41, v178, v179
    v_cvt_pk_bf16_f32 v42, v180, v181
    v_cvt_pk_bf16_f32 v43, v182, v183
    buffer_store_dwordx4 v[40:43], v17, s[16:19], s28 offen offset:0 sc1
    v_cvt_pk_bf16_f32 v44, v184, v185
    v_cvt_pk_bf16_f32 v45, v186, v187
    v_cvt_pk_bf16_f32 v46, v188, v189
    v_cvt_pk_bf16_f32 v47, v190, v191
    buffer_store_dwordx4 v[44:47], v17, s[16:19], s28 offen offset:512 sc1
    s_add_u32 s28, s28, 8192
    v_cvt_pk_bf16_f32 v48, v192, v193
    v_cvt_pk_bf16_f32 v49, v194, v195
    v_cvt_pk_bf16_f32 v50, v196, v197
    v_cvt_pk_bf16_f32 v51, v198, v199
    buffer_store_dwordx4 v[48:51], v17, s[16:19], s28 offen offset:0 sc1
    v_cvt_pk_bf16_f32 v52, v200, v201
    v_cvt_pk_bf16_f32 v53, v202, v203
    v_cvt_pk_bf16_f32 v54, v204, v205
    v_cvt_pk_bf16_f32 v55, v206, v207
    buffer_store_dwordx4 v[52:55], v17, s[16:19], s28 offen offset:512 sc1
    s_add_u32 s28, s28, 8192
    v_cvt_pk_bf16_f32 v56, v208, v209
    v_cvt_pk_bf16_f32 v57, v210, v211
    v_cvt_pk_bf16_f32 v58, v212, v213
    v_cvt_pk_bf16_f32 v59, v214, v215
    buffer_store_dwordx4 v[56:59], v17, s[16:19], s28 offen offset:0 sc1
    v_cvt_pk_bf16_f32 v60, v216, v217
    v_cvt_pk_bf16_f32 v61, v218, v219
    v_cvt_pk_bf16_f32 v62, v220, v221
    v_cvt_pk_bf16_f32 v63, v222, v223
    buffer_store_dwordx4 v[60:63], v17, s[16:19], s28 offen offset:512 sc1
    s_add_u32 s28, s28, 8192
    s_branch L_k1_end
L_k1_bucket:
    s_load_dwordx4 s[20:23], s[0:1], 8
    s_load_dwordx2 s[16:17], s[0:1], 88
    s_mov_b32 s6, 1280000
    s_mov_b32 s7, 0x00020000
    s_mov_b32 s10, 1280000
    s_mov_b32 s11, 0x00020000
    s_mov_b32 s18, 0x10000000
    s_mov_b32 s19, 0x00020000
    s_mul_i32 s24, s2, 20000
    v_lshlrev_b32 v1, 4, v0
    v_mov_b32 v4, 0
    v_mov_b32 v5, 0
    v_mov_b32 v6, 0
    v_mov_b32 v7, 0
    ds_write_b128 v1, v[4:7] offset:0
    v_mov_b32 v8, 1
    s_waitcnt lgkmcnt(0)
    s_mov_b32 s4, s20
    s_and_b32 s5, s21, 0xffff
    s_mov_b32 s8, s22
    s_and_b32 s9, s23, 0xffff
    s_and_b32 s17, s17, 0xffff
    s_mov_b32 s25, s24
    buffer_load_dwordx4 v[32:35], v1, s[8:11], s25 offen
    s_add_u32 s25, s25, 4096
    buffer_load_dwordx4 v[36:39], v1, s[8:11], s25 offen
    s_add_u32 s25, s25, 4096
    buffer_load_dwordx4 v[40:43], v1, s[8:11], s25 offen
    s_add_u32 s25, s25, 4096
    buffer_load_dwordx4 v[44:47], v1, s[8:11], s25 offen
    s_add_u32 s25, s25, 4096
    buffer_load_dwordx4 v[48:51], v1, s[8:11], s25 offen
    s_add_u32 s25, s25, 4096
    buffer_load_dwordx4 v[52:55], v1, s[4:7], s24 offen
    s_add_u32 s24, s24, 4096
    buffer_load_dwordx4 v[56:59], v1, s[4:7], s24 offen
    s_add_u32 s24, s24, 4096
    buffer_load_dwordx4 v[60:63], v1, s[4:7], s24 offen
    s_add_u32 s24, s24, 4096
    buffer_load_dwordx4 v[64:67], v1, s[4:7], s24 offen
    s_add_u32 s24, s24, 4096
    buffer_load_dwordx4 v[68:71], v1, s[4:7], s24 offen
    s_add_u32 s24, s24, 4096
    s_barrier
    v_cmp_gt_u32 vcc, 226, v0
    v_mov_b32 v9, 10239
    s_waitcnt vmcnt(9)
    v_lshrrev_b32 v92, 4, v32
    v_lshlrev_b32 v92, 2, v92
    ds_add_rtn_u32 v72, v92, v8 offset:0
    v_lshrrev_b32 v93, 4, v33
    v_lshlrev_b32 v93, 2, v93
    ds_add_rtn_u32 v73, v93, v8 offset:0
    v_lshrrev_b32 v94, 4, v34
    v_lshlrev_b32 v94, 2, v94
    ds_add_rtn_u32 v74, v94, v8 offset:0
    v_lshrrev_b32 v95, 4, v35
    v_lshlrev_b32 v95, 2, v95
    ds_add_rtn_u32 v75, v95, v8 offset:0
    s_waitcnt vmcnt(8)
    v_lshrrev_b32 v96, 4, v36
    v_lshlrev_b32 v96, 2, v96
    ds_add_rtn_u32 v76, v96, v8 offset:0
    v_lshrrev_b32 v97, 4, v37
    v_lshlrev_b32 v97, 2, v97
    ds_add_rtn_u32 v77, v97, v8 offset:0
    v_lshrrev_b32 v98, 4, v38
    v_lshlrev_b32 v98, 2, v98
    ds_add_rtn_u32 v78, v98, v8 offset:0
    v_lshrrev_b32 v99, 4, v39
    v_lshlrev_b32 v99, 2, v99
    ds_add_rtn_u32 v79, v99, v8 offset:0
    s_waitcnt vmcnt(7)
    v_lshrrev_b32 v100, 4, v40
    v_lshlrev_b32 v100, 2, v100
    ds_add_rtn_u32 v80, v100, v8 offset:0
    v_lshrrev_b32 v101, 4, v41
    v_lshlrev_b32 v101, 2, v101
    ds_add_rtn_u32 v81, v101, v8 offset:0
    v_lshrrev_b32 v102, 4, v42
    v_lshlrev_b32 v102, 2, v102
    ds_add_rtn_u32 v82, v102, v8 offset:0
    v_lshrrev_b32 v103, 4, v43
    v_lshlrev_b32 v103, 2, v103
    ds_add_rtn_u32 v83, v103, v8 offset:0
    s_waitcnt vmcnt(6)
    v_lshrrev_b32 v104, 4, v44
    v_lshlrev_b32 v104, 2, v104
    ds_add_rtn_u32 v84, v104, v8 offset:0
    v_lshrrev_b32 v105, 4, v45
    v_lshlrev_b32 v105, 2, v105
    ds_add_rtn_u32 v85, v105, v8 offset:0
    v_lshrrev_b32 v106, 4, v46
    v_lshlrev_b32 v106, 2, v106
    ds_add_rtn_u32 v86, v106, v8 offset:0
    v_lshrrev_b32 v107, 4, v47
    v_lshlrev_b32 v107, 2, v107
    ds_add_rtn_u32 v87, v107, v8 offset:0
    s_waitcnt vmcnt(5)
    v_cndmask_b32 v48, v9, v48, vcc
    v_lshrrev_b32 v108, 4, v48
    v_lshlrev_b32 v108, 2, v108
    ds_add_rtn_u32 v88, v108, v8 offset:0
    v_cndmask_b32 v49, v9, v49, vcc
    v_lshrrev_b32 v109, 4, v49
    v_lshlrev_b32 v109, 2, v109
    ds_add_rtn_u32 v89, v109, v8 offset:0
    v_cndmask_b32 v50, v9, v50, vcc
    v_lshrrev_b32 v110, 4, v50
    v_lshlrev_b32 v110, 2, v110
    ds_add_rtn_u32 v90, v110, v8 offset:0
    v_cndmask_b32 v51, v9, v51, vcc
    v_lshrrev_b32 v111, 4, v51
    v_lshlrev_b32 v111, 2, v111
    ds_add_rtn_u32 v91, v111, v8 offset:0
    s_waitcnt vmcnt(0)
    v_and_b32 v4, 12, v32
    v_lshl_or_b32 v52, v52, 8, v4
    v_and_b32 v32, 3, v32
    v_lshl_or_b32 v52, v32, 4, v52
    v_and_b32 v4, 12, v33
    v_lshl_or_b32 v53, v53, 8, v4
    v_and_b32 v33, 3, v33
    v_lshl_or_b32 v53, v33, 4, v53
    v_and_b32 v4, 12, v34
    v_lshl_or_b32 v54, v54, 8, v4
    v_and_b32 v34, 3, v34
    v_lshl_or_b32 v54, v34, 4, v54
    v_and_b32 v4, 12, v35
    v_lshl_or_b32 v55, v55, 8, v4
    v_and_b32 v35, 3, v35
    v_lshl_or_b32 v55, v35, 4, v55
    v_and_b32 v4, 12, v36
    v_lshl_or_b32 v56, v56, 8, v4
    v_and_b32 v36, 3, v36
    v_lshl_or_b32 v56, v36, 4, v56
    v_and_b32 v4, 12, v37
    v_lshl_or_b32 v57, v57, 8, v4
    v_and_b32 v37, 3, v37
    v_lshl_or_b32 v57, v37, 4, v57
    v_and_b32 v4, 12, v38
    v_lshl_or_b32 v58, v58, 8, v4
    v_and_b32 v38, 3, v38
    v_lshl_or_b32 v58, v38, 4, v58
    v_and_b32 v4, 12, v39
    v_lshl_or_b32 v59, v59, 8, v4
    v_and_b32 v39, 3, v39
    v_lshl_or_b32 v59, v39, 4, v59
    v_and_b32 v4, 12, v40
    v_lshl_or_b32 v60, v60, 8, v4
    v_and_b32 v40, 3, v40
    v_lshl_or_b32 v60, v40, 4, v60
    v_and_b32 v4, 12, v41
    v_lshl_or_b32 v61, v61, 8, v4
    v_and_b32 v41, 3, v41
    v_lshl_or_b32 v61, v41, 4, v61
    v_and_b32 v4, 12, v42
    v_lshl_or_b32 v62, v62, 8, v4
    v_and_b32 v42, 3, v42
    v_lshl_or_b32 v62, v42, 4, v62
    v_and_b32 v4, 12, v43
    v_lshl_or_b32 v63, v63, 8, v4
    v_and_b32 v43, 3, v43
    v_lshl_or_b32 v63, v43, 4, v63
    v_and_b32 v4, 12, v44
    v_lshl_or_b32 v64, v64, 8, v4
    v_and_b32 v44, 3, v44
    v_lshl_or_b32 v64, v44, 4, v64
    v_and_b32 v4, 12, v45
    v_lshl_or_b32 v65, v65, 8, v4
    v_and_b32 v45, 3, v45
    v_lshl_or_b32 v65, v45, 4, v65
    v_and_b32 v4, 12, v46
    v_lshl_or_b32 v66, v66, 8, v4
    v_and_b32 v46, 3, v46
    v_lshl_or_b32 v66, v46, 4, v66
    v_and_b32 v4, 12, v47
    v_lshl_or_b32 v67, v67, 8, v4
    v_and_b32 v47, 3, v47
    v_lshl_or_b32 v67, v47, 4, v67
    v_and_b32 v4, 12, v48
    v_lshl_or_b32 v68, v68, 8, v4
    v_and_b32 v48, 3, v48
    v_lshl_or_b32 v68, v48, 4, v68
    v_and_b32 v4, 12, v49
    v_lshl_or_b32 v69, v69, 8, v4
    v_and_b32 v49, 3, v49
    v_lshl_or_b32 v69, v49, 4, v69
    v_and_b32 v4, 12, v50
    v_lshl_or_b32 v70, v70, 8, v4
    v_and_b32 v50, 3, v50
    v_lshl_or_b32 v70, v50, 4, v70
    v_and_b32 v4, 12, v51
    v_lshl_or_b32 v71, v71, 8, v4
    v_and_b32 v51, 3, v51
    v_lshl_or_b32 v71, v51, 4, v71
    s_waitcnt lgkmcnt(0)
    s_barrier
    v_and_b32 v2, 63, v0
    v_mul_u32_u24 v3, 40, v2
    v_lshrrev_b32 v10, 6, v0
    ds_read_b64 v[112:113], v3 offset:0
    ds_read_b64 v[114:115], v3 offset:8
    ds_read_b64 v[116:117], v3 offset:16
    ds_read_b64 v[118:119], v3 offset:24
    ds_read_b64 v[120:121], v3 offset:32
    v_readfirstlane_b32 s43, v10
    v_mul_u32_u24 v10, 2560, v10
    v_add_u32 v3, v3, v10
    v_mul_u32_u24 v28, 40, v2
    s_mul_i32 s29, s2, 2560
    s_add_u32 s29, s29, 51380224
    s_lshl_b32 s43, s43, 4
    s_lshl_b64 s[30:31], 0xffff, s43
    v_add_u32 v92, v92, v10
    v_add_u32 v93, v93, v10
    v_add_u32 v94, v94, v10
    v_add_u32 v95, v95, v10
    v_add_u32 v96, v96, v10
    v_add_u32 v97, v97, v10
    v_add_u32 v98, v98, v10
    v_add_u32 v99, v99, v10
    v_add_u32 v100, v100, v10
    v_add_u32 v101, v101, v10
    v_add_u32 v102, v102, v10
    v_add_u32 v103, v103, v10
    v_add_u32 v104, v104, v10
    v_add_u32 v105, v105, v10
    v_add_u32 v106, v106, v10
    v_add_u32 v107, v107, v10
    v_add_u32 v108, v108, v10
    v_add_u32 v109, v109, v10
    v_add_u32 v110, v110, v10
    v_add_u32 v111, v111, v10
    s_waitcnt lgkmcnt(0)
    v_mov_b32 v122, 0
    v_add_u32 v123, v122, v112
    v_add_u32 v124, v123, v113
    v_add_u32 v125, v124, v114
    v_add_u32 v126, v125, v115
    v_add_u32 v127, v126, v116
    v_add_u32 v128, v127, v117
    v_add_u32 v129, v128, v118
    v_add_u32 v130, v129, v119
    v_add_u32 v131, v130, v120
    v_add_u32 v12, v131, v121
    v_mov_b32 v13, v12
    s_nop 1
    v_add_u32_dpp v13, v13, v13 row_shr:1 row_mask:0xf bank_mask:0xf
    s_nop 1
    v_add_u32_dpp v13, v13, v13 row_shr:2 row_mask:0xf bank_mask:0xf
    s_nop 1
    v_add_u32_dpp v13, v13, v13 row_shr:4 row_mask:0xf bank_mask:0xf
    s_nop 1
    v_add_u32_dpp v13, v13, v13 row_shr:8 row_mask:0xf bank_mask:0xf
    s_nop 1
    v_add_u32_dpp v13, v13, v13 row_bcast:15 row_mask:0xa bank_mask:0xf
    s_nop 1
    v_add_u32_dpp v13, v13, v13 row_bcast:31 row_mask:0xc bank_mask:0xf
    v_sub_u32 v13, v13, v12
    v_add_u32 v122, v122, v13
    v_add_u32 v123, v123, v13
    v_add_u32 v124, v124, v13
    v_add_u32 v125, v125, v13
    v_add_u32 v126, v126, v13
    v_add_u32 v127, v127, v13
    v_add_u32 v128, v128, v13
    v_add_u32 v129, v129, v13
    v_add_u32 v130, v130, v13
    v_add_u32 v131, v131, v13
    ds_write_b64 v3, v[122:123] offset:4096
    ds_write_b64 v3, v[124:125] offset:4104
    ds_write_b64 v3, v[126:127] offset:4112
    ds_write_b64 v3, v[128:129] offset:4120
    ds_write_b64 v3, v[130:131] offset:4128
    v_lshl_or_b32 v112, v112, 16, v122
    v_lshl_or_b32 v113, v113, 16, v123
    v_lshl_or_b32 v114, v114, 16, v124
    v_lshl_or_b32 v115, v115, 16, v125
    v_lshl_or_b32 v116, v116, 16, v126
    v_lshl_or_b32 v117, v117, 16, v127
    v_lshl_or_b32 v118, v118, 16, v128
    v_lshl_or_b32 v119, v119, 16, v129
    v_lshl_or_b32 v120, v120, 16, v130
    v_lshl_or_b32 v121, v121, 16, v131
    s_mov_b64 exec, s[30:31]
    buffer_store_dwordx2 v[112:113], v28, s[16:19], s29 offen offset:0 sc1
    buffer_store_dwordx2 v[114:115], v28, s[16:19], s29 offen offset:8 sc1
    buffer_store_dwordx2 v[116:117], v28, s[16:19], s29 offen offset:16 sc1
    buffer_store_dwordx2 v[118:119], v28, s[16:19], s29 offen offset:24 sc1
    buffer_store_dwordx2 v[120:121], v28, s[16:19], s29 offen offset:32 sc1
    s_mov_b64 exec, -1
    s_waitcnt lgkmcnt(0)
    ds_read_b32 v92, v92 offset:4096
    ds_read_b32 v93, v93 offset:4096
    ds_read_b32 v94, v94 offset:4096
    ds_read_b32 v95, v95 offset:4096
    ds_read_b32 v96, v96 offset:4096
    ds_read_b32 v97, v97 offset:4096
    ds_read_b32 v98, v98 offset:4096
    ds_read_b32 v99, v99 offset:4096
    ds_read_b32 v100, v100 offset:4096
    ds_read_b32 v101, v101 offset:4096
    ds_read_b32 v102, v102 offset:4096
    ds_read_b32 v103, v103 offset:4096
    ds_read_b32 v104, v104 offset:4096
    ds_read_b32 v105, v105 offset:4096
    ds_read_b32 v106, v106 offset:4096
    ds_read_b32 v107, v107 offset:4096
    ds_read_b32 v108, v108 offset:4096
    ds_read_b32 v109, v109 offset:4096
    ds_read_b32 v110, v110 offset:4096
    ds_read_b32 v111, v111 offset:4096
    s_waitcnt lgkmcnt(0)
    v_add_lshl_u32 v92, v92, v72, 2
    ds_write_b32 v92, v52 offset:16384
    v_add_lshl_u32 v93, v93, v73, 2
    ds_write_b32 v93, v53 offset:16384
    v_add_lshl_u32 v94, v94, v74, 2
    ds_write_b32 v94, v54 offset:16384
    v_add_lshl_u32 v95, v95, v75, 2
    ds_write_b32 v95, v55 offset:16384
    v_add_lshl_u32 v96, v96, v76, 2
    ds_write_b32 v96, v56 offset:16384
    v_add_lshl_u32 v97, v97, v77, 2
    ds_write_b32 v97, v57 offset:16384
    v_add_lshl_u32 v98, v98, v78, 2
    ds_write_b32 v98, v58 offset:16384
    v_add_lshl_u32 v99, v99, v79, 2
    ds_write_b32 v99, v59 offset:16384
    v_add_lshl_u32 v100, v100, v80, 2
    ds_write_b32 v100, v60 offset:16384
    v_add_lshl_u32 v101, v101, v81, 2
    ds_write_b32 v101, v61 offset:16384
    v_add_lshl_u32 v102, v102, v82, 2
    ds_write_b32 v102, v62 offset:16384
    v_add_lshl_u32 v103, v103, v83, 2
    ds_write_b32 v103, v63 offset:16384
    v_add_lshl_u32 v104, v104, v84, 2
    ds_write_b32 v104, v64 offset:16384
    v_add_lshl_u32 v105, v105, v85, 2
    ds_write_b32 v105, v65 offset:16384
    v_add_lshl_u32 v106, v106, v86, 2
    ds_write_b32 v106, v66 offset:16384
    v_add_lshl_u32 v107, v107, v87, 2
    ds_write_b32 v107, v67 offset:16384
    v_add_lshl_u32 v108, v108, v88, 2
    ds_write_b32 v108, v68 offset:16384
    v_add_lshl_u32 v109, v109, v89, 2
    ds_write_b32 v109, v69 offset:16384
    v_add_lshl_u32 v110, v110, v90, 2
    ds_write_b32 v110, v70 offset:16384
    v_add_lshl_u32 v111, v111, v91, 2
    ds_write_b32 v111, v71 offset:16384
    s_waitcnt lgkmcnt(0)
    s_barrier
    ds_read_b128 v[32:35], v1 offset:16384
    ds_read_b128 v[36:39], v1 offset:20480
    ds_read_b128 v[40:43], v1 offset:24576
    ds_read_b128 v[44:47], v1 offset:28672
    ds_read_b128 v[48:51], v1 offset:32768
    s_mul_i32 s24, s2, 20480
    s_add_u32 s24, s24, 52428800
    s_waitcnt lgkmcnt(4)
    buffer_store_dwordx4 v[32:35], v1, s[16:19], s24 offen sc1
    s_add_u32 s24, s24, 4096
    s_waitcnt lgkmcnt(3)
    buffer_store_dwordx4 v[36:39], v1, s[16:19], s24 offen sc1
    s_add_u32 s24, s24, 4096
    s_waitcnt lgkmcnt(2)
    buffer_store_dwordx4 v[40:43], v1, s[16:19], s24 offen sc1
    s_add_u32 s24, s24, 4096
    s_waitcnt lgkmcnt(1)
    buffer_store_dwordx4 v[44:47], v1, s[16:19], s24 offen sc1
    s_add_u32 s24, s24, 4096
    s_waitcnt lgkmcnt(0)
    buffer_store_dwordx4 v[48:51], v1, s[16:19], s24 offen sc1
    s_add_u32 s24, s24, 4096
L_k1_end:
L_k1_exit:
    s_endpgm
.text
.globl k2_attn_kernel
.p2align 8
.type k2_attn_kernel,@function
k2_attn_kernel:
    s_cmp_ge_u32 s2, 240
    s_cbranch_scc1 L_k2_end
    s_getpc_b64 s[92:93]
L_k2_pc:
    s_sub_u32 s92, s92, L_k2_pc - k2_attn_kernel
    s_subb_u32 s93, s93, 0
    s_lshr_b32 s94, s2, 3
    s_lshl_b32 s94, s94, 10
    s_min_u32 s94, s94, L_k2_last - k2_attn_kernel - 1024
    v_lshl_add_u32 v60, v0, 2, s94
    global_load_dword v49, v60, s[92:93]
    s_load_dwordx2 s[4:5], s[0:1], 88
    s_load_dwordx2 s[32:33], s[0:1], 0
    s_load_dwordx2 s[36:37], s[0:1], 24
    s_load_dwordx2 s[40:41], s[0:1], 72
    v_lshrrev_b32 v1, 6, v0
    v_and_b32 v2, 63, v0
    v_readfirstlane_b32 s8, v1
    v_lshlrev_b32 v21, 4, v2
    v_lshlrev_b32 v12, 2, v2
    s_and_b32 s15, s2, 7
    s_lshr_b32 s16, s2, 3
    s_mul_i32 s14, s15, 29
    s_add_u32 s14, s14, s16
    s_cmp_eq_u32 s15, 7
    s_addc_u32 s14, s14, 0
    s_add_u32 s13, s15, 234
    s_cmp_lt_u32 s15, 6
    s_cselect_b32 s30, 29, 99
    s_cmp_eq_u32 s16, s30
    s_cselect_b32 s15, s13, s14
    s_mul_i32 s14, s15, 10923
    s_lshr_b32 s14, s14, 16
    s_mul_i32 s13, s14, 6
    s_sub_u32 s13, s15, s13
    s_mov_b32 s6, 0x10000000
    s_mov_b32 s7, 0x00020000
    s_mov_b32 s34, 2560000
    s_mov_b32 s35, 0x00020000
    s_mov_b32 s38, 20000
    s_mov_b32 s39, 0x00020000
    s_mov_b32 s42, 2560000
    s_mov_b32 s43, 0x00020000
    s_mov_b32 s46, 2560000
    s_mov_b32 s47, 0x00020000
    s_mov_b32 s12, 0x4b800000
    s_lshl_b32 s15, s8, 12
    s_mul_i32 s26, s13, 425984
    s_add_u32 s26, s26, s15
    s_mov_b32 s16, 4194304
    s_cmp_lt_u32 s8, 2
    s_cselect_b32 s16, s16, 8372224
    s_add_u32 s26, s26, s16
    s_lshl_b32 s20, s14, 16
    s_lshl_b32 s16, s8, 14
    s_add_u32 s20, s20, s16
    s_add_u32 s20, s20, 0
    s_add_u32 s21, s20, 0x1000
    s_add_u32 s22, s20, 0x2000
    s_add_u32 s23, s20, 0x3000
    s_mul_i32 s16, s14, 6
    s_add_u32 s16, s16, s13
    s_lshl_b32 s24, s16, 16
    s_lshl_b32 s15, s8, 14
    s_add_u32 s24, s24, s15
    s_add_u32 s24, s24, 16777216
    s_lshl_b32 s25, s16, 11
    s_lshl_b32 s15, s8, 9
    s_add_u32 s25, s25, s15
    s_add_u32 s25, s25, 41943040
    s_lshl_b32 s15, s8, 2
    s_lshl_b32 s31, 4161, s13
    s_lshr_b32 s31, s31, s15
    s_add_u32 s15, s24, 0
    s_bitcmp1_b32 s31, 0
    s_cselect_b32 s56, 0x7fff0000, s15
    s_add_u32 s15, s24, 4096
    s_bitcmp1_b32 s31, 1
    s_cselect_b32 s57, 0x7fff0000, s15
    s_add_u32 s15, s24, 8192
    s_bitcmp1_b32 s31, 2
    s_cselect_b32 s58, 0x7fff0000, s15
    s_add_u32 s15, s24, 12288
    s_bitcmp1_b32 s31, 3
    s_cselect_b32 s59, 0x7fff0000, s15
    v_mov_b32 v15, 0x7fff0000
    v_mov_b32 v51, 0
    s_cmp_lt_u32 s13, 2
    s_cselect_b32 s15, 0, 0x7fff0000
    v_add_u32 v18, s15, v21
    s_mov_b32 s27, 51
    s_mov_b32 s30, 0
    s_add_u32 s15, s27, 1
    s_cmp_lt_u32 s8, 2
    s_cselect_b32 s16, 0, 1
    s_add_u32 s15, s15, s16
    s_lshl_b32 s15, s15, 13
    s_add_u32 s82, s26, s15
    s_sub_u32 s82, s82, 4096
    s_mov_b32 s83, 0x00020000
    s_mov_b32 s48, 52428800
    s_mov_b32 s28, 6750208
    s_mov_b32 s29, 10944512
    s_add_u32 s3, s29, 4096
    s_mov_b32 s49, 72
    s_lshl_b32 s54, s14, 7
    s_add_u32 s54, s54, 50331648
    s_mul_i32 s15, s8, 6
    s_add_u32 s15, s15, s13
    s_lshl_b32 s16, s14, 4
    s_add_u32 s16, s16, s15
    s_cmp_lt_u32 s15, 16
    s_cselect_b32 s53, -1, 0
    s_cmp_lt_u32 s16, 625
    s_cselect_b32 s53, s53, 0
    s_lshl_b32 s52, s16, 2
    s_add_u32 s52, s52, 51380224
    s_mul_i32 s15, s8, 5376
    s_add_u32 s15, s15, 131328
    v_mov_b32 v17, s15
    s_add_u32 s15, s15, 64
    v_add_u32 v16, s15, v12
    v_mov_b32 v25, 0x7fffffff
    v_mov_b32 v4, 0
    v_mov_b32 v5, 131072
    ds_write_b32 v5, v4
    v_and_b32 v2, 63, v0
    v_and_b32 v3, 15, v0
    v_lshl_add_u32 v3, v3, 2, v17
    v_mov_b32 v4, 0
    v_lshl_add_u32 v5, v2, 4, v17
    ds_write_b32 v3, v4
    v_mov_b32 v4, 0x40000000
    ds_write_b32 v16, v4
    v_mov_b32 v6, 2147483392
    v_mov_b32 v7, 2147483392
    v_mov_b32 v8, 2147483392
    v_mov_b32 v9, 2147483392
    v_lshl_add_u32 v3, v2, 3, v17
    ds_write_b128 v5, v[6:9] offset:384
    ds_write_b128 v5, v[6:9] offset:1408
    ds_write_b128 v5, v[6:9] offset:2432
    ds_write_b128 v5, v[6:9] offset:3456
    ds_write_b64 v3, v[6:7] offset:4480
    s_waitcnt lgkmcnt(0)
    s_and_b32 s5, s5, 0xffff
    s_and_b32 s33, s33, 0xffff
    s_and_b32 s37, s37, 0xffff
    s_and_b32 s41, s41, 0xffff
    s_mov_b32 s80, s4
    s_mov_b32 s81, s5
    s_add_u32 s44, s4, 12582912
    s_addc_u32 s45, s5, 0
    v_mul_u32_u24 v11, 640, v12
    v_mov_b32 v50, 0
L_k2_restart:
    s_mov_b32 s9, s26
    s_lshl_b32 s10, s8, 12
    s_mov_b32 m0, s10
    s_mov_b32 s17, s27
    v_mov_b32 v120, 0
    v_mov_b32 v121, 0
    v_mov_b32 v122, 0
    v_mov_b32 v123, 0
    v_mov_b32 v124, 0
    v_mov_b32 v125, 0
    v_mov_b32 v126, 0
    v_mov_b32 v127, 0
    buffer_load_dwordx4 a[80:83], v21, s[4:7], s28 offen offset:0
    buffer_load_dwordx4 a[84:87], v21, s[4:7], s28 offen offset:1024
    buffer_load_dwordx4 a[88:91], v21, s[4:7], s28 offen offset:2048
    buffer_load_dwordx4 a[92:95], v21, s[4:7], s28 offen offset:3072
    buffer_load_dwordx4 a[0:3], v21, s[4:7], s20 offen offset:0
    buffer_load_dwordx4 a[4:7], v21, s[4:7], s20 offen offset:1024
    v_mfma_f32_32x32x16_bf16 v[240:255], v[120:123], v[120:123], 0
    buffer_load_dwordx4 a[8:11], v21, s[4:7], s20 offen offset:2048
    buffer_load_dwordx4 a[12:15], v21, s[4:7], s20 offen offset:3072
    v_mfma_f32_32x32x16_bf16 v[224:239], v[120:123], v[120:123], 0
    buffer_load_dwordx4 a[16:19], v21, s[4:7], s21 offen offset:0
    buffer_load_dwordx4 a[20:23], v21, s[4:7], s21 offen offset:1024
    v_mfma_f32_32x32x16_bf16 v[208:223], v[120:123], v[120:123], 0
    buffer_load_dwordx4 a[24:27], v21, s[4:7], s21 offen offset:2048
    buffer_load_dwordx4 a[28:31], v21, s[4:7], s21 offen offset:3072
    v_mfma_f32_32x32x16_bf16 v[192:207], v[120:123], v[120:123], 0
    buffer_load_dwordx4 a[32:35], v21, s[4:7], s22 offen offset:0
    buffer_load_dwordx4 a[36:39], v21, s[4:7], s22 offen offset:1024
    v_mfma_f32_32x32x16_bf16 v[176:191], v[120:123], v[120:123], 0
    buffer_load_dwordx4 a[40:43], v21, s[4:7], s22 offen offset:2048
    buffer_load_dwordx4 a[44:47], v21, s[4:7], s22 offen offset:3072
    v_mfma_f32_32x32x16_bf16 v[160:175], v[120:123], v[120:123], 0
    buffer_load_dwordx4 a[48:51], v21, s[4:7], s23 offen offset:0
    buffer_load_dwordx4 a[52:55], v21, s[4:7], s23 offen offset:1024
    v_mfma_f32_32x32x16_bf16 v[144:159], v[120:123], v[120:123], 0
    buffer_load_dwordx4 a[56:59], v21, s[4:7], s23 offen offset:2048
    buffer_load_dwordx4 a[60:63], v21, s[4:7], s23 offen offset:3072
    v_mfma_f32_32x32x16_bf16 v[128:143], v[120:123], v[120:123], 0
    buffer_load_dwordx4 v21, s[80:83], s9 offen offset:0 lds
    buffer_load_dwordx4 v21, s[80:83], s9 offen offset:1024 lds
    buffer_load_dwordx4 v21, s[80:83], s9 offen offset:2048 lds
    buffer_load_dwordx4 v21, s[80:83], s9 offen offset:3072 lds
    s_add_u32 s10, s10, 0x4000
    s_and_b32 m0, s10, 0x1ffff
    s_add_u32 s9, s9, 0x2000
    buffer_load_dwordx4 a[96:99], v18, s[4:7], s29 offen offset:0
    buffer_load_dwordx4 a[100:103], v18, s[4:7], s29 offen offset:1024
    buffer_load_dwordx4 a[104:107], v18, s[4:7], s29 offen offset:2048
    buffer_load_dwordx4 a[108:111], v18, s[4:7], s29 offen offset:3072
    buffer_load_dwordx4 a[112:115], v18, s[4:7], s3 offen offset:0
    buffer_load_dwordx4 a[116:119], v18, s[4:7], s3 offen offset:1024
    buffer_load_dwordx4 a[120:123], v18, s[4:7], s3 offen offset:2048
    buffer_load_dwordx4 a[124:127], v18, s[4:7], s3 offen offset:3072
    buffer_load_dwordx4 v21, s[80:83], s9 offen offset:0 lds
    buffer_load_dwordx4 v21, s[80:83], s9 offen offset:1024 lds
    buffer_load_dwordx4 v21, s[80:83], s9 offen offset:2048 lds
    buffer_load_dwordx4 v21, s[80:83], s9 offen offset:3072 lds
    s_add_u32 s10, s10, 0x4000
    s_and_b32 m0, s10, 0x1ffff
    s_add_u32 s9, s9, 0x2000
    s_cmp_lg_u32 s30, 0
    s_cbranch_scc1 L_k2_nosetup
    v_bfe_u32 v2, v0, 2, 2
    v_and_b32 v3, 3, v0
    v_bfe_u32 v4, v0, 4, 2
    s_lshl_b32 s15, s8, 6
    s_sub_u32 s16, s15, 12
    v_lshlrev_b32 v13, 4, v3
    v_add_u32 v13, s16, v13
    v_lshlrev_b32 v5, 4, v2
    v_sub_u32 v13, v13, v5
    v_lshlrev_b32 v14, 4, v2
    v_lshl_add_u32 v14, v4, 6, v14
    v_add_u32 v14, 131328, v14
    v_and_b32 v6, 15, v0
    v_and_b32 v7, 1, v6
    v_lshlrev_b32 v7, 4, v7
    v_mov_b32 v8, 0x3f80
    v_lshlrev_b32 v7, v7, v8
    v_lshrrev_b32 v6, 1, v6
    v_cmp_eq_u32 s[64:65], 0, v6
    v_cmp_eq_u32 s[66:67], 1, v6
    v_cmp_eq_u32 s[68:69], 2, v6
    v_cmp_eq_u32 s[70:71], 3, v6
    v_cmp_eq_u32 s[72:73], 4, v6
    v_cmp_eq_u32 s[74:75], 5, v6
    v_cmp_eq_u32 s[76:77], 6, v6
    v_cmp_eq_u32 s[78:79], 7, v6
    v_cndmask_b32 v56, 0, v7, s[64:65]
    v_cndmask_b32 v57, 0, v7, s[66:67]
    v_cndmask_b32 v58, 0, v7, s[68:69]
    v_cndmask_b32 v59, 0, v7, s[70:71]
    v_cndmask_b32 v60, 0, v7, s[72:73]
    v_cndmask_b32 v61, 0, v7, s[74:75]
    v_cndmask_b32 v62, 0, v7, s[76:77]
    v_cndmask_b32 v63, 0, v7, s[78:79]
    v_accvgpr_write_b32 a200, v56
    v_accvgpr_write_b32 a201, v57
    v_accvgpr_write_b32 a202, v58
    v_accvgpr_write_b32 a203, v59
    v_accvgpr_write_b32 a204, v60
    v_accvgpr_write_b32 a205, v61
    v_accvgpr_write_b32 a206, v62
    v_accvgpr_write_b32 a207, v63
    v_mfma_f32_32x32x16_bf16 a[128:143], v[120:123], v[120:123], 0
    v_mfma_f32_32x32x16_bf16 a[144:159], v[120:123], v[120:123], 0
    v_mfma_f32_32x32x16_bf16 a[160:175], v[120:123], v[120:123], 0
    v_mfma_f32_32x32x16_bf16 a[176:191], v[120:123], v[120:123], 0
    v_mfma_f32_16x16x32_bf16 a[192:195], v[120:123], v[120:123], 0
    v_mfma_f32_16x16x32_bf16 a[196:199], v[120:123], v[120:123], 0
L_k2_nosetup:
    v_mov_b32 v52, 0
    v_mov_b32 v53, 0
    v_mov_b32 v54, 0
    v_mov_b32 v55, 0
    v_add_u32 v20, 0x4000, v21
    s_waitcnt vmcnt(16)
    v_mfma_f32_16x16x32_bf16 v[68:71], a[80:83], a[0:3], 0
    v_mfma_f32_16x16x32_bf16 v[76:79], a[80:83], a[16:19], 0
    buffer_load_dwordx4 v21, s[80:83], s9 offen offset:0 lds
    v_mfma_f32_16x16x32_bf16 v[84:87], a[80:83], a[32:35], 0
    v_mfma_f32_16x16x32_bf16 v[92:95], a[80:83], a[48:51], 0
    v_mfma_f32_16x16x32_bf16 v[68:71], a[84:87], a[4:7], v[68:71]
    v_mfma_f32_16x16x32_bf16 v[76:79], a[84:87], a[20:23], v[76:79]
    buffer_load_dwordx4 v21, s[80:83], s9 offen offset:1024 lds
    v_mfma_f32_16x16x32_bf16 v[84:87], a[84:87], a[36:39], v[84:87]
    v_mfma_f32_16x16x32_bf16 v[92:95], a[84:87], a[52:55], v[92:95]
    v_mfma_f32_16x16x32_bf16 v[68:71], a[88:91], a[8:11], v[68:71]
    v_mfma_f32_16x16x32_bf16 v[76:79], a[88:91], a[24:27], v[76:79]
    buffer_load_dwordx4 v21, s[80:83], s9 offen offset:2048 lds
    v_mfma_f32_16x16x32_bf16 v[84:87], a[88:91], a[40:43], v[84:87]
    v_mfma_f32_16x16x32_bf16 v[92:95], a[88:91], a[56:59], v[92:95]
    v_mfma_f32_16x16x32_bf16 v[68:71], a[92:95], a[12:15], v[68:71]
    v_mfma_f32_16x16x32_bf16 v[76:79], a[92:95], a[28:31], v[76:79]
    buffer_load_dwordx4 v21, s[80:83], s9 offen offset:3072 lds
    s_add_u32 s10, s10, 0x4000
    s_and_b32 m0, s10, 0x1ffff
    s_add_u32 s9, s9, 0x2000
    v_mfma_f32_16x16x32_bf16 v[84:87], a[92:95], a[44:47], v[84:87]
    v_mfma_f32_16x16x32_bf16 v[92:95], a[92:95], a[60:63], v[92:95]
    s_waitcnt vmcnt(16)
    s_barrier
    ds_read_b128 a[64:67], v21 offset:0
    ds_read_b128 a[68:71], v21 offset:1024
    ds_read_b128 a[72:75], v21 offset:2048
    ds_read_b128 a[76:79], v21 offset:3072
    ds_read_b128 a[80:83], v21 offset:4096
    ds_read_b128 a[84:87], v21 offset:5120
    ds_read_b128 a[88:91], v21 offset:6144
    ds_read_b128 a[92:95], v21 offset:7168
    s_nop 1
    v_max3_f32 v26, v68, v69, v70
    v_max3_f32 v27, v76, v77, v78
    v_max3_f32 v28, v84, v85, v86
    v_max3_f32 v29, v92, v93, v94
    v_max_f32 v26, v26, v71
    v_max_f32 v27, v27, v79
    v_max_f32 v28, v28, v87
    v_max_f32 v29, v29, v95
    v_mov_b32 v30, v26
    v_mov_b32 v31, v27
    v_mov_b32 v32, v28
    v_mov_b32 v33, v29
    s_nop 0
    v_permlane32_swap_b32 v26, v30
    v_permlane32_swap_b32 v27, v31
    v_permlane32_swap_b32 v28, v32
    v_permlane32_swap_b32 v29, v33
    s_nop 0
    v_max_f32 v26, v26, v30
    v_max_f32 v27, v27, v31
    v_max_f32 v28, v28, v32
    v_max_f32 v29, v29, v33
    v_mov_b32 v30, v26
    v_mov_b32 v31, v27
    v_mov_b32 v32, v28
    v_mov_b32 v33, v29
    s_nop 0
    v_permlane16_swap_b32 v26, v30
    v_permlane16_swap_b32 v27, v31
    v_permlane16_swap_b32 v28, v32
    v_permlane16_swap_b32 v29, v33
    s_nop 0
    v_max_f32 v26, v26, v30
    v_max_f32 v27, v27, v31
    v_max_f32 v28, v28, v32
    v_max_f32 v29, v29, v33
    v_sub_f32 v96, 0, v26
    v_sub_f32 v97, 0, v26
    v_sub_f32 v98, 0, v26
    v_sub_f32 v99, 0, v26
    v_sub_f32 v100, 0, v27
    v_sub_f32 v101, 0, v27
    v_sub_f32 v102, 0, v27
    v_sub_f32 v103, 0, v27
    v_sub_f32 v104, 0, v28
    v_sub_f32 v105, 0, v28
    v_sub_f32 v106, 0, v28
    v_sub_f32 v107, 0, v28
    v_sub_f32 v108, 0, v29
    v_sub_f32 v109, 0, v29
    v_sub_f32 v110, 0, v29
    v_sub_f32 v111, 0, v29
    s_cmp_lt_u32 s13, 2
    s_cbranch_scc1 L_lo
L_lo_ret:
    s_waitcnt lgkmcnt(0)
    v_mfma_f32_16x16x32_bf16 v[64:67], a[64:67], a[0:3], v[96:99]
    buffer_load_dwordx4 v21, s[80:83], s9 offen offset:0 lds
    v_mfma_f32_16x16x32_bf16 v[72:75], a[64:67], a[16:19], v[100:103]
    v_mfma_f32_16x16x32_bf16 v[68:71], a[80:83], a[0:3], v[96:99]
    buffer_load_dwordx4 v21, s[80:83], s9 offen offset:1024 lds
    v_mfma_f32_16x16x32_bf16 v[76:79], a[80:83], a[16:19], v[100:103]
    v_mfma_f32_16x16x32_bf16 v[64:67], a[68:71], a[4:7], v[64:67]
    buffer_load_dwordx4 v21, s[80:83], s9 offen offset:2048 lds
    v_mfma_f32_16x16x32_bf16 v[72:75], a[68:71], a[20:23], v[72:75]
    v_mfma_f32_16x16x32_bf16 v[68:71], a[84:87], a[4:7], v[68:71]
    buffer_load_dwordx4 v21, s[80:83], s9 offen offset:3072 lds
    s_add_u32 s10, s10, 0x4000
    s_and_b32 m0, s10, 0x1ffff
    s_add_u32 s9, s9, 0x2000
    v_mfma_f32_16x16x32_bf16 v[76:79], a[84:87], a[20:23], v[76:79]
    v_mfma_f32_16x16x32_bf16 v[64:67], a[72:75], a[8:11], v[64:67]
    buffer_load_dwordx4 v21, s[80:83], s9 offen offset:0 lds
    v_mfma_f32_16x16x32_bf16 v[72:75], a[72:75], a[24:27], v[72:75]
    v_mfma_f32_16x16x32_bf16 v[68:71], a[88:91], a[8:11], v[68:71]
    buffer_load_dwordx4 v21, s[80:83], s9 offen offset:1024 lds
    v_mfma_f32_16x16x32_bf16 v[76:79], a[88:91], a[24:27], v[76:79]
    v_mfma_f32_16x16x32_bf16 v[64:67], a[76:79], a[12:15], v[64:67]
    buffer_load_dwordx4 v21, s[80:83], s9 offen offset:2048 lds
    v_mfma_f32_16x16x32_bf16 v[72:75], a[76:79], a[28:31], v[72:75]
    v_mfma_f32_16x16x32_bf16 v[68:71], a[92:95], a[12:15], v[68:71]
    buffer_load_dwordx4 v21, s[80:83], s9 offen offset:3072 lds
    s_add_u32 s10, s10, 0x4000
    s_and_b32 m0, s10, 0x1ffff
    s_add_u32 s9, s9, 0x2000
    v_mfma_f32_16x16x32_bf16 v[76:79], a[92:95], a[28:31], v[76:79]
    s_cmp_lg_u32 s30, 0
    s_cbranch_scc1 L_safe
    buffer_load_dword v50, v11, s[4:7], s52 offen
    s_mov_b32 s11, 2
    s_mov_b32 s18, 0
.p2align 6
L_body_m:
    s_waitcnt vmcnt(12)
    s_barrier
    v_mfma_f32_16x16x32_bf16 v[192:195], a[96:99], v[120:123], v[192:195]
    v_exp_f32 v64, v64
    v_mfma_f32_16x16x32_bf16 v[196:199], a[100:103], v[120:123], v[196:199]
    buffer_load_dwordx4 v21, s[80:83], s9 offen offset:0 lds
    v_mfma_f32_16x16x32_bf16 v[200:203], a[104:107], v[120:123], v[200:203]
    v_exp_f32 v65, v65
    v_mfma_f32_16x16x32_bf16 v[204:207], a[108:111], v[120:123], v[204:207]
    buffer_load_dwordx4 v21, s[80:83], s9 offen offset:1024 lds
    v_mfma_f32_16x16x32_bf16 v[208:211], a[112:115], v[120:123], v[208:211]
    v_exp_f32 v66, v66
    v_mfma_f32_16x16x32_bf16 v[212:215], a[116:119], v[120:123], v[212:215]
    v_exp_f32 v67, v67
    v_mfma_f32_16x16x32_bf16 v[216:219], a[120:123], v[120:123], v[216:219]
    v_exp_f32 v68, v68
    v_mfma_f32_16x16x32_bf16 v[220:223], a[124:127], v[120:123], v[220:223]
    v_add_f32 v52, v52, v64
    v_add_f32 v52, v52, v65
    v_mfma_f32_16x16x32_bf16 v[224:227], a[96:99], v[124:127], v[224:227]
    ds_read_b128 a[96:99], v20 offset:8192
    v_add_f32 v52, v52, v66
    v_mfma_f32_16x16x32_bf16 v[228:231], a[100:103], v[124:127], v[228:231]
    ds_read_b128 a[100:103], v20 offset:9216
    v_cvt_pk_bf16_f32 v112, v64, v65
    v_mfma_f32_16x16x32_bf16 v[232:235], a[104:107], v[124:127], v[232:235]
    ds_read_b128 a[104:107], v20 offset:10240
    v_add_f32 v52, v52, v67
    v_mfma_f32_16x16x32_bf16 v[236:239], a[108:111], v[124:127], v[236:239]
    ds_read_b128 a[108:111], v20 offset:11264
    v_cvt_pk_bf16_f32 v113, v66, v67
    v_mfma_f32_16x16x32_bf16 v[240:243], a[112:115], v[124:127], v[240:243]
    v_exp_f32 v69, v69
    v_mfma_f32_16x16x32_bf16 v[244:247], a[116:119], v[124:127], v[244:247]
    ds_read_b128 a[112:115], v20 offset:12288
    v_add_f32 v52, v52, v68
    v_mfma_f32_16x16x32_bf16 v[248:251], a[120:123], v[124:127], v[248:251]
    v_exp_f32 v70, v70
    v_mfma_f32_16x16x32_bf16 v[252:255], a[124:127], v[124:127], v[252:255]
    ds_read_b128 a[116:119], v20 offset:13312
    v_cvt_pk_bf16_f32 v114, v68, v69
    v_mfma_f32_16x16x32_bf16 v[80:83], a[64:67], a[32:35], v[104:107]
    v_exp_f32 v71, v71
    v_mfma_f32_16x16x32_bf16 v[88:91], a[64:67], a[48:51], v[108:111]
    ds_read_b128 a[120:123], v20 offset:14336
    v_add_f32 v52, v52, v69
    v_mfma_f32_16x16x32_bf16 v[84:87], a[80:83], a[32:35], v[104:107]
    v_exp_f32 v72, v72
    v_mfma_f32_16x16x32_bf16 v[92:95], a[80:83], a[48:51], v[108:111]
    ds_read_b128 a[124:127], v20 offset:15360
    v_cvt_pk_bf16_f32 v115, v70, v71
    v_mfma_f32_16x16x32_bf16 v[80:83], a[68:71], a[36:39], v[80:83]
    v_exp_f32 v73, v73
    v_mfma_f32_16x16x32_bf16 v[88:91], a[68:71], a[52:55], v[88:91]
    v_exp_f32 v74, v74
    v_mfma_f32_16x16x32_bf16 v[84:87], a[84:87], a[36:39], v[84:87]
    ds_read_b128 a[64:67], v20 offset:0
    v_add_f32 v52, v52, v70
    v_mfma_f32_16x16x32_bf16 v[92:95], a[84:87], a[52:55], v[92:95]
    ds_read_b128 a[80:83], v20 offset:4096
    v_add_f32 v52, v52, v71
    v_mfma_f32_16x16x32_bf16 v[80:83], a[72:75], a[40:43], v[80:83]
    v_exp_f32 v75, v75
    v_mfma_f32_16x16x32_bf16 v[88:91], a[72:75], a[56:59], v[88:91]
    ds_read_b128 a[68:71], v20 offset:1024
    v_cvt_pk_bf16_f32 v116, v72, v73
    v_mfma_f32_16x16x32_bf16 v[84:87], a[88:91], a[40:43], v[84:87]
    v_exp_f32 v76, v76
    v_mfma_f32_16x16x32_bf16 v[92:95], a[88:91], a[56:59], v[92:95]
    v_add_f32 v53, v53, v72
    v_cvt_pk_bf16_f32 v117, v74, v75
    v_mfma_f32_16x16x32_bf16 v[80:83], a[76:79], a[44:47], v[80:83]
    ds_read_b128 a[84:87], v20 offset:5120
    v_add_f32 v53, v53, v73
    v_mfma_f32_16x16x32_bf16 v[88:91], a[76:79], a[60:63], v[88:91]
    v_exp_f32 v77, v77
    v_mfma_f32_16x16x32_bf16 v[84:87], a[92:95], a[44:47], v[84:87]
    ds_read_b128 a[72:75], v20 offset:2048
    v_cvt_pk_bf16_f32 v118, v76, v77
    v_mfma_f32_16x16x32_bf16 v[92:95], a[92:95], a[60:63], v[92:95]
    v_exp_f32 v78, v78
    s_waitcnt lgkmcnt(5)
    v_mfma_f32_16x16x32_bf16 v[128:131], a[96:99], v[112:115], v[128:131]
    v_exp_f32 v80, v80
    v_mfma_f32_16x16x32_bf16 v[132:135], a[100:103], v[112:115], v[132:135]
    v_exp_f32 v81, v81
    v_mfma_f32_16x16x32_bf16 v[136:139], a[104:107], v[112:115], v[136:139]
    buffer_load_dwordx4 v21, s[80:83], s9 offen offset:2048 lds
    v_mfma_f32_16x16x32_bf16 v[140:143], a[108:111], v[112:115], v[140:143]
    v_exp_f32 v82, v82
    v_mfma_f32_16x16x32_bf16 v[144:147], a[112:115], v[112:115], v[144:147]
    buffer_load_dwordx4 v21, s[80:83], s9 offen offset:3072 lds
    v_mfma_f32_16x16x32_bf16 v[148:151], a[116:119], v[112:115], v[148:151]
    v_exp_f32 v79, v79
    v_mfma_f32_16x16x32_bf16 v[152:155], a[120:123], v[112:115], v[152:155]
    s_add_u32 s10, s10, 0x4000
    v_cvt_pk_bf16_f32 v119, v78, v79
    v_exp_f32 v83, v83
    v_mfma_f32_16x16x32_bf16 v[156:159], a[124:127], v[112:115], v[156:159]
    s_and_b32 m0, s10, 0x1ffff
    v_add_f32 v53, v53, v74
    v_add_f32 v54, v54, v80
    v_mfma_f32_16x16x32_bf16 v[160:163], a[96:99], v[116:119], v[160:163]
    s_add_u32 s9, s9, 0x2000
    v_exp_f32 v84, v84
    v_mfma_f32_16x16x32_bf16 v[164:167], a[100:103], v[116:119], v[164:167]
    s_sub_u32 s11, s11, 1
    ds_read_b128 a[88:91], v20 offset:6144
    v_add_f32 v53, v53, v75
    v_mfma_f32_16x16x32_bf16 v[168:171], a[104:107], v[116:119], v[168:171]
    ds_read_b128 a[76:79], v20 offset:3072
    ds_read_b128 a[92:95], v20 offset:7168
    v_exp_f32 v85, v85
    v_mfma_f32_16x16x32_bf16 v[172:175], a[108:111], v[116:119], v[172:175]
    v_add_f32 v54, v54, v81
    v_add_f32 v53, v53, v76
    v_mfma_f32_16x16x32_bf16 v[176:179], a[112:115], v[116:119], v[176:179]
    v_exp_f32 v86, v86
    v_mfma_f32_16x16x32_bf16 v[180:183], a[116:119], v[116:119], v[180:183]
    v_add_f32 v54, v54, v82
    v_add_f32 v53, v53, v77
    v_mfma_f32_16x16x32_bf16 v[184:187], a[120:123], v[116:119], v[184:187]
    v_add_f32 v54, v54, v83
    v_add_f32 v53, v53, v78
    v_add_f32 v53, v53, v79
    v_mfma_f32_16x16x32_bf16 v[188:191], a[124:127], v[116:119], v[188:191]
    v_exp_f32 v87, v87
    s_waitcnt lgkmcnt(0)
    v_mfma_f32_16x16x32_bf16 v[64:67], a[64:67], a[0:3], v[96:99]
    v_add_f32 v54, v54, v84
    v_add_f32 v54, v54, v85
    v_mfma_f32_16x16x32_bf16 v[72:75], a[64:67], a[16:19], v[100:103]
    v_exp_f32 v88, v88
    v_mfma_f32_16x16x32_bf16 v[68:71], a[80:83], a[0:3], v[96:99]
    v_exp_f32 v89, v89
    v_mfma_f32_16x16x32_bf16 v[76:79], a[80:83], a[16:19], v[100:103]
    v_add_f32 v54, v54, v86
    v_add_f32 v54, v54, v87
    v_mfma_f32_16x16x32_bf16 v[64:67], a[68:71], a[4:7], v[64:67]
    v_exp_f32 v90, v90
    v_mfma_f32_16x16x32_bf16 v[72:75], a[68:71], a[20:23], v[72:75]
    v_cvt_pk_bf16_f32 v120, v80, v81
    v_add_f32 v55, v55, v88
    v_mfma_f32_16x16x32_bf16 v[68:71], a[84:87], a[4:7], v[68:71]
    v_exp_f32 v91, v91
    v_mfma_f32_16x16x32_bf16 v[76:79], a[84:87], a[20:23], v[76:79]
    v_cvt_pk_bf16_f32 v121, v82, v83
    v_add_f32 v55, v55, v89
    v_mfma_f32_16x16x32_bf16 v[64:67], a[72:75], a[8:11], v[64:67]
    v_exp_f32 v92, v92
    v_mfma_f32_16x16x32_bf16 v[72:75], a[72:75], a[24:27], v[72:75]
    v_cvt_pk_bf16_f32 v122, v84, v85
    v_add_f32 v55, v55, v90
    v_mfma_f32_16x16x32_bf16 v[68:71], a[88:91], a[8:11], v[68:71]
    v_exp_f32 v93, v93
    v_mfma_f32_16x16x32_bf16 v[76:79], a[88:91], a[24:27], v[76:79]
    v_cvt_pk_bf16_f32 v123, v86, v87
    v_add_f32 v55, v55, v91
    v_mfma_f32_16x16x32_bf16 v[64:67], a[76:79], a[12:15], v[64:67]
    v_cvt_pk_bf16_f32 v124, v88, v89
    v_add_f32 v55, v55, v92
    v_mfma_f32_16x16x32_bf16 v[72:75], a[76:79], a[28:31], v[72:75]
    v_exp_f32 v94, v94
    v_exp_f32 v95, v95
    v_mfma_f32_16x16x32_bf16 v[68:71], a[92:95], a[12:15], v[68:71]
    s_cmp_lg_u32 s11, 0
    v_cvt_pk_bf16_f32 v125, v90, v91
    v_add_f32 v55, v55, v93
    v_cvt_pk_bf16_f32 v126, v92, v93
    v_cvt_pk_bf16_f32 v127, v94, v95
    v_mfma_f32_16x16x32_bf16 v[76:79], a[92:95], a[28:31], v[76:79]
    v_add_u32 v20, 0x4000, v20
    v_add_f32 v55, v55, v94
    v_and_b32 v20, 0x1ffff, v20
    v_add_f32 v55, v55, v95
    s_cbranch_scc1 L_body_m
    s_add_u32 s18, s18, 1
    s_cmp_eq_u32 s18, 4
    s_cbranch_scc1 L_loop_done
    s_cmp_eq_u32 s18, 3
    s_cbranch_scc1 L_ev_g
    s_cmp_eq_u32 s18, 2
    s_cbranch_scc1 L_ev_b
    s_waitcnt vmcnt(8)
    v_and_b32 v50, s53, v50
    v_and_b32 v2, 63, v0
    v_mul_u32_u24 v2, 20480, v2
    v_and_b32 v3, 0xffff, v50
    v_lshl_add_u32 v51, v3, 2, v2
    v_lshrrev_b32 v50, 16, v50
    buffer_load_dwordx4 v[26:29], v51, s[4:7], s48 offen offset:0
    buffer_load_dwordx4 v[30:33], v51, s[4:7], s48 offen offset:16
    buffer_load_dwordx4 v[34:37], v51, s[4:7], s48 offen offset:32
    buffer_load_dwordx4 v[38:41], v51, s[4:7], s48 offen offset:48
    buffer_load_dwordx4 v[42:45], v51, s[4:7], s48 offen offset:64
    buffer_load_dwordx4 v[46:49], v51, s[4:7], s48 offen offset:80
    s_mov_b32 s11, 3
    s_branch L_body_m
L_ev_b:
    s_waitcnt vmcnt(12)
    v_mov_b32 v12, 1
    v_cmp_lt_u32 s[64:65], 0, v50
    v_cmp_lt_u32 s[66:67], 1, v50
    v_cmp_lt_u32 s[68:69], 2, v50
    v_cmp_lt_u32 s[70:71], 3, v50
    v_cmp_lt_u32 s[72:73], 4, v50
    v_cmp_lt_u32 s[74:75], 5, v50
    v_cmp_lt_u32 s[76:77], 6, v50
    v_cmp_lt_u32 s[78:79], 7, v50
    v_and_or_b32 v56, v26, 60, v17
    v_and_or_b32 v57, v27, 60, v17
    v_and_or_b32 v58, v28, 60, v17
    v_and_or_b32 v59, v29, 60, v17
    v_and_or_b32 v60, v30, 60, v17
    v_and_or_b32 v61, v31, 60, v17
    v_and_or_b32 v62, v32, 60, v17
    v_and_or_b32 v63, v33, 60, v17
    v_cndmask_b32 v56, v16, v56, s[64:65]
    ds_add_rtn_u32 v4, v56, v12
    v_cndmask_b32 v57, v16, v57, s[66:67]
    ds_add_rtn_u32 v5, v57, v12
    v_cndmask_b32 v58, v16, v58, s[68:69]
    ds_add_rtn_u32 v6, v58, v12
    v_cndmask_b32 v59, v16, v59, s[70:71]
    ds_add_rtn_u32 v7, v59, v12
    v_cndmask_b32 v60, v16, v60, s[72:73]
    ds_add_rtn_u32 v8, v60, v12
    v_cndmask_b32 v61, v16, v61, s[74:75]
    ds_add_rtn_u32 v9, v61, v12
    v_cndmask_b32 v62, v16, v62, s[76:77]
    ds_add_rtn_u32 v10, v62, v12
    v_cndmask_b32 v63, v16, v63, s[78:79]
    ds_add_rtn_u32 v11, v63, v12
    s_waitcnt lgkmcnt(7)
    v_min_u32 v4, s49, v4
    v_lshl_add_u32 v56, v4, 6, v56
    ds_write_b32 v56, v26 offset:384
    s_waitcnt lgkmcnt(7)
    v_min_u32 v5, s49, v5
    v_lshl_add_u32 v57, v5, 6, v57
    ds_write_b32 v57, v27 offset:384
    s_waitcnt lgkmcnt(7)
    v_min_u32 v6, s49, v6
    v_lshl_add_u32 v58, v6, 6, v58
    ds_write_b32 v58, v28 offset:384
    s_waitcnt lgkmcnt(7)
    v_min_u32 v7, s49, v7
    v_lshl_add_u32 v59, v7, 6, v59
    ds_write_b32 v59, v29 offset:384
    s_waitcnt lgkmcnt(7)
    v_min_u32 v8, s49, v8
    v_lshl_add_u32 v60, v8, 6, v60
    ds_write_b32 v60, v30 offset:384
    s_waitcnt lgkmcnt(7)
    v_min_u32 v9, s49, v9
    v_lshl_add_u32 v61, v9, 6, v61
    ds_write_b32 v61, v31 offset:384
    s_waitcnt lgkmcnt(7)
    v_min_u32 v10, s49, v10
    v_lshl_add_u32 v62, v10, 6, v62
    ds_write_b32 v62, v32 offset:384
    s_waitcnt lgkmcnt(7)
    v_min_u32 v11, s49, v11
    v_lshl_add_u32 v63, v11, 6, v63
    ds_write_b32 v63, v33 offset:384
    v_cmp_lt_u32 s[64:65], 8, v50
    v_cmp_lt_u32 s[66:67], 9, v50
    v_cmp_lt_u32 s[68:69], 10, v50
    v_cmp_lt_u32 s[70:71], 11, v50
    v_cmp_lt_u32 s[72:73], 12, v50
    v_cmp_lt_u32 s[74:75], 13, v50
    v_cmp_lt_u32 s[76:77], 14, v50
    v_cmp_lt_u32 s[78:79], 15, v50
    v_and_or_b32 v56, v34, 60, v17
    v_and_or_b32 v57, v35, 60, v17
    v_and_or_b32 v58, v36, 60, v17
    v_and_or_b32 v59, v37, 60, v17
    v_and_or_b32 v60, v38, 60, v17
    v_and_or_b32 v61, v39, 60, v17
    v_and_or_b32 v62, v40, 60, v17
    v_and_or_b32 v63, v41, 60, v17
    s_cmp_eq_u64 s[64:65], 0
    s_cbranch_scc1 L_ev_built
    v_cndmask_b32 v56, v16, v56, s[64:65]
    ds_add_rtn_u32 v4, v56, v12
    v_cndmask_b32 v57, v16, v57, s[66:67]
    ds_add_rtn_u32 v5, v57, v12
    v_cndmask_b32 v58, v16, v58, s[68:69]
    ds_add_rtn_u32 v6, v58, v12
    v_cndmask_b32 v59, v16, v59, s[70:71]
    ds_add_rtn_u32 v7, v59, v12
    v_cndmask_b32 v60, v16, v60, s[72:73]
    ds_add_rtn_u32 v8, v60, v12
    v_cndmask_b32 v61, v16, v61, s[74:75]
    ds_add_rtn_u32 v9, v61, v12
    v_cndmask_b32 v62, v16, v62, s[76:77]
    ds_add_rtn_u32 v10, v62, v12
    v_cndmask_b32 v63, v16, v63, s[78:79]
    ds_add_rtn_u32 v11, v63, v12
    s_waitcnt lgkmcnt(7)
    v_min_u32 v4, s49, v4
    v_lshl_add_u32 v56, v4, 6, v56
    ds_write_b32 v56, v34 offset:384
    s_waitcnt lgkmcnt(7)
    v_min_u32 v5, s49, v5
    v_lshl_add_u32 v57, v5, 6, v57
    ds_write_b32 v57, v35 offset:384
    s_waitcnt lgkmcnt(7)
    v_min_u32 v6, s49, v6
    v_lshl_add_u32 v58, v6, 6, v58
    ds_write_b32 v58, v36 offset:384
    s_waitcnt lgkmcnt(7)
    v_min_u32 v7, s49, v7
    v_lshl_add_u32 v59, v7, 6, v59
    ds_write_b32 v59, v37 offset:384
    s_waitcnt lgkmcnt(7)
    v_min_u32 v8, s49, v8
    v_lshl_add_u32 v60, v8, 6, v60
    ds_write_b32 v60, v38 offset:384
    s_waitcnt lgkmcnt(7)
    v_min_u32 v9, s49, v9
    v_lshl_add_u32 v61, v9, 6, v61
    ds_write_b32 v61, v39 offset:384
    s_waitcnt lgkmcnt(7)
    v_min_u32 v10, s49, v10
    v_lshl_add_u32 v62, v10, 6, v62
    ds_write_b32 v62, v40 offset:384
    s_waitcnt lgkmcnt(7)
    v_min_u32 v11, s49, v11
    v_lshl_add_u32 v63, v11, 6, v63
    ds_write_b32 v63, v41 offset:384
    v_cmp_lt_u32 s[64:65], 16, v50
    v_cmp_lt_u32 s[66:67], 17, v50
    v_cmp_lt_u32 s[68:69], 18, v50
    v_cmp_lt_u32 s[70:71], 19, v50
    v_cmp_lt_u32 s[72:73], 20, v50
    v_cmp_lt_u32 s[74:75], 21, v50
    v_cmp_lt_u32 s[76:77], 22, v50
    v_cmp_lt_u32 s[78:79], 23, v50
    v_and_or_b32 v56, v42, 60, v17
    v_and_or_b32 v57, v43, 60, v17
    v_and_or_b32 v58, v44, 60, v17
    v_and_or_b32 v59, v45, 60, v17
    v_and_or_b32 v60, v46, 60, v17
    v_and_or_b32 v61, v47, 60, v17
    v_and_or_b32 v62, v48, 60, v17
    v_and_or_b32 v63, v49, 60, v17
    s_cmp_eq_u64 s[64:65], 0
    s_cbranch_scc1 L_ev_built
    v_cndmask_b32 v56, v16, v56, s[64:65]
    ds_add_rtn_u32 v4, v56, v12
    v_cndmask_b32 v57, v16, v57, s[66:67]
    ds_add_rtn_u32 v5, v57, v12
    v_cndmask_b32 v58, v16, v58, s[68:69]
    ds_add_rtn_u32 v6, v58, v12
    v_cndmask_b32 v59, v16, v59, s[70:71]
    ds_add_rtn_u32 v7, v59, v12
    v_cndmask_b32 v60, v16, v60, s[72:73]
    ds_add_rtn_u32 v8, v60, v12
    v_cndmask_b32 v61, v16, v61, s[74:75]
    ds_add_rtn_u32 v9, v61, v12
    v_cndmask_b32 v62, v16, v62, s[76:77]
    ds_add_rtn_u32 v10, v62, v12
    v_cndmask_b32 v63, v16, v63, s[78:79]
    ds_add_rtn_u32 v11, v63, v12
    s_waitcnt lgkmcnt(7)
    v_min_u32 v4, s49, v4
    v_lshl_add_u32 v56, v4, 6, v56
    ds_write_b32 v56, v42 offset:384
    s_waitcnt lgkmcnt(7)
    v_min_u32 v5, s49, v5
    v_lshl_add_u32 v57, v5, 6, v57
    ds_write_b32 v57, v43 offset:384
    s_waitcnt lgkmcnt(7)
    v_min_u32 v6, s49, v6
    v_lshl_add_u32 v58, v6, 6, v58
    ds_write_b32 v58, v44 offset:384
    s_waitcnt lgkmcnt(7)
    v_min_u32 v7, s49, v7
    v_lshl_add_u32 v59, v7, 6, v59
    ds_write_b32 v59, v45 offset:384
    s_waitcnt lgkmcnt(7)
    v_min_u32 v8, s49, v8
    v_lshl_add_u32 v60, v8, 6, v60
    ds_write_b32 v60, v46 offset:384
    s_waitcnt lgkmcnt(7)
    v_min_u32 v9, s49, v9
    v_lshl_add_u32 v61, v9, 6, v61
    ds_write_b32 v61, v47 offset:384
    s_waitcnt lgkmcnt(7)
    v_min_u32 v10, s49, v10
    v_lshl_add_u32 v62, v10, 6, v62
    ds_write_b32 v62, v48 offset:384
    s_waitcnt lgkmcnt(7)
    v_min_u32 v11, s49, v11
    v_lshl_add_u32 v63, v11, 6, v63
    ds_write_b32 v63, v49 offset:384
L_ev_built:
    v_and_b32 v2, 15, v0
    v_lshl_add_u32 v2, v2, 2, v17
    ds_read_b32 v3, v2
    v_cmp_lt_u32 s[64:65], 24, v50
    s_waitcnt lgkmcnt(0)
    v_cmp_lt_u32 vcc, s49, v3
    s_nop 3
    s_or_b64 vcc, vcc, s[64:65]
    s_cbranch_vccnz L_car_e
    v_mov_b32 v50, 0
L_ev_ret:
    s_mov_b32 s11, 1
    s_branch L_body_m
L_ev_g:
    v_and_b32 v6, 15, v0
    v_bfe_u32 v7, v0, 4, 2
    v_mul_u32_u24 v7, 5376, v7
    v_lshl_add_u32 v7, v6, 2, v7
    v_add_u32 v7, 131328, v7
    ds_read_b32 v9, v7
    s_waitcnt lgkmcnt(0)
    v_max_u32_dpp v9, v9, v9 row_shr:1 row_mask:0xf bank_mask:0xf
    s_nop 1
    v_max_u32_dpp v9, v9, v9 row_shr:2 row_mask:0xf bank_mask:0xf
    s_nop 1
    v_max_u32_dpp v9, v9, v9 row_shr:4 row_mask:0xf bank_mask:0xf
    s_nop 1
    v_max_u32_dpp v9, v9, v9 row_shr:8 row_mask:0xf bank_mask:0xf
    s_nop 1
    v_max_u32_dpp v9, v9, v9 row_bcast:15 row_mask:0xa bank_mask:0xf
    s_nop 1
    v_max_u32_dpp v9, v9, v9 row_bcast:31 row_mask:0xc bank_mask:0xf
    s_nop 1
    v_readlane_b32 s50, v9, 63
    s_nop 3
    s_min_u32 s51, s50, 72
    s_add_u32 s51, s51, 3
    s_lshr_b32 s51, s51, 2
    s_min_u32 s11, s51, 15
    s_max_u32 s11, s11, 1
    s_sub_u32 s51, s51, s11
    s_mul_i32 s15, s11, 3
    s_sub_u32 s17, s17, s15
    s_sub_u32 s17, s17, 6
    v_bfe_u32 v2, v0, 2, 2
    v_and_b32 v3, 3, v0
    v_bfe_u32 v4, v0, 4, 2
    s_lshl_b32 s15, s8, 6
    s_lshl_b32 s16, s14, 4
    s_add_u32 s16, s16, s13
    s_lshl_b32 s52, s16, 12
    s_add_u32 s52, s52, s15
    v_lshrrev_b32 v5, 1, v4
    v_lshl_add_u32 v5, v5, 2, v2
    v_and_b32 v6, 1, v4
    v_lshlrev_b32 v15, 8, v5
    v_lshl_add_u32 v15, v6, 5, v15
    v_lshl_add_u32 v15, v3, 3, v15
    v_add_u32 v15, s52, v15
    v_add_u32 v10, 24576, v15
    v_add_u32 v11, 49152, v15
    s_lshl_b32 s52, s16, 5
    v_and_b32 v5, 15, v0
    v_lshlrev_b32 v5, 1, v5
    v_add_u32 v5, s52, v5
    s_lshl_b32 s52, s8, 13
    s_add_u32 s52, s52, 15728640
    s_add_u32 s16, s52, 4096
    s_waitcnt vmcnt(0)
    buffer_load_dwordx2 a[208:209], v15, s[32:35], 0 offen offset:0
    buffer_load_dwordx2 a[210:211], v15, s[32:35], 0 offen offset:2048
    buffer_load_ushort a220, v5, s[36:39], 0 offen offset:0
    buffer_load_dwordx2 a[212:213], v10, s[32:35], 0 offen offset:0
    buffer_load_dwordx2 a[214:215], v10, s[32:35], 0 offen offset:2048
    buffer_load_ushort a221, v5, s[36:39], 0 offen offset:192
    buffer_load_dwordx2 a[216:217], v11, s[32:35], 0 offen offset:0
    buffer_load_dwordx2 a[218:219], v11, s[32:35], 0 offen offset:2048
    buffer_load_ushort a222, v5, s[36:39], 0 offen offset:384
.p2align 6
L_body_g0:
    s_waitcnt vmcnt(24)
    s_barrier
    v_mfma_f32_16x16x32_bf16 v[192:195], a[96:99], v[120:123], v[192:195]
    v_exp_f32 v64, v64
    v_mfma_f32_16x16x32_bf16 v[196:199], a[100:103], v[120:123], v[196:199]
    buffer_load_dwordx4 v21, s[80:83], s9 offen offset:0 lds
    v_mfma_f32_16x16x32_bf16 v[200:203], a[104:107], v[120:123], v[200:203]
    ds_read_b128 v[26:29], v14 offset:384
    v_add_f32 v52, v52, v64
    v_mfma_f32_16x16x32_bf16 v[204:207], a[108:111], v[120:123], v[204:207]
    buffer_load_dwordx4 v21, s[80:83], s9 offen offset:1024 lds
    v_mfma_f32_16x16x32_bf16 v[208:211], a[112:115], v[120:123], v[208:211]
    v_exp_f32 v65, v65
    v_mfma_f32_16x16x32_bf16 v[212:215], a[116:119], v[120:123], v[212:215]
    v_exp_f32 v66, v66
    v_mfma_f32_16x16x32_bf16 v[216:219], a[120:123], v[120:123], v[216:219]
    v_exp_f32 v67, v67
    v_mfma_f32_16x16x32_bf16 v[220:223], a[124:127], v[120:123], v[220:223]
    v_exp_f32 v68, v68
    v_mfma_f32_16x16x32_bf16 v[224:227], a[96:99], v[124:127], v[224:227]
    ds_read_b128 a[96:99], v20 offset:8192
    v_add_f32 v52, v52, v65
    v_mfma_f32_16x16x32_bf16 v[228:231], a[100:103], v[124:127], v[228:231]
    ds_read_b128 a[100:103], v20 offset:9216
    v_cvt_pk_bf16_f32 v112, v64, v65
    v_mfma_f32_16x16x32_bf16 v[232:235], a[104:107], v[124:127], v[232:235]
    ds_read_b128 a[104:107], v20 offset:10240
    v_add_f32 v52, v52, v66
    v_mfma_f32_16x16x32_bf16 v[236:239], a[108:111], v[124:127], v[236:239]
    ds_read_b128 a[108:111], v20 offset:11264
    v_cvt_pk_bf16_f32 v113, v66, v67
    v_mfma_f32_16x16x32_bf16 v[240:243], a[112:115], v[124:127], v[240:243]
    v_exp_f32 v69, v69
    v_mfma_f32_16x16x32_bf16 v[244:247], a[116:119], v[124:127], v[244:247]
    ds_read_b128 a[112:115], v20 offset:12288
    v_add_f32 v52, v52, v67
    v_mfma_f32_16x16x32_bf16 v[248:251], a[120:123], v[124:127], v[248:251]
    v_exp_f32 v70, v70
    v_mfma_f32_16x16x32_bf16 v[252:255], a[124:127], v[124:127], v[252:255]
    ds_read_b128 a[116:119], v20 offset:13312
    v_cvt_pk_bf16_f32 v114, v68, v69
    v_mfma_f32_16x16x32_bf16 v[80:83], a[64:67], a[32:35], v[104:107]
    v_exp_f32 v71, v71
    v_mfma_f32_16x16x32_bf16 v[88:91], a[64:67], a[48:51], v[108:111]
    ds_read_b128 a[120:123], v20 offset:14336
    v_add_f32 v52, v52, v68
    v_mfma_f32_16x16x32_bf16 v[84:87], a[80:83], a[32:35], v[104:107]
    v_exp_f32 v72, v72
    v_mfma_f32_16x16x32_bf16 v[92:95], a[80:83], a[48:51], v[108:111]
    ds_read_b128 a[124:127], v20 offset:15360
    v_cvt_pk_bf16_f32 v115, v70, v71
    v_mfma_f32_16x16x32_bf16 v[80:83], a[68:71], a[36:39], v[80:83]
    v_exp_f32 v73, v73
    v_mfma_f32_16x16x32_bf16 v[88:91], a[68:71], a[52:55], v[88:91]
    v_exp_f32 v74, v74
    v_mfma_f32_16x16x32_bf16 v[84:87], a[84:87], a[36:39], v[84:87]
    ds_read_b128 a[64:67], v20 offset:0
    v_add_f32 v52, v52, v69
    v_mfma_f32_16x16x32_bf16 v[92:95], a[84:87], a[52:55], v[92:95]
    v_exp_f32 v75, v75
    v_mfma_f32_16x16x32_bf16 v[80:83], a[72:75], a[40:43], v[80:83]
    v_add_f32 v52, v52, v70
    v_cvt_pk_bf16_f32 v116, v72, v73
    v_mfma_f32_16x16x32_bf16 v[88:91], a[72:75], a[56:59], v[88:91]
    ds_read_b128 a[80:83], v20 offset:4096
    v_add_f32 v52, v52, v71
    v_mfma_f32_16x16x32_bf16 v[84:87], a[88:91], a[40:43], v[84:87]
    v_exp_f32 v76, v76
    v_mfma_f32_16x16x32_bf16 v[92:95], a[88:91], a[56:59], v[92:95]
    ds_read_b128 a[68:71], v20 offset:1024
    v_cvt_pk_bf16_f32 v117, v74, v75
    v_mfma_f32_16x16x32_bf16 v[80:83], a[76:79], a[44:47], v[80:83]
    v_exp_f32 v77, v77
    v_mfma_f32_16x16x32_bf16 v[88:91], a[76:79], a[60:63], v[88:91]
    v_add_f32 v53, v53, v72
    v_cvt_pk_bf16_f32 v118, v76, v77
    v_mfma_f32_16x16x32_bf16 v[84:87], a[92:95], a[44:47], v[84:87]
    ds_read_b128 a[84:87], v20 offset:5120
    v_add_f32 v53, v53, v73
    v_mfma_f32_16x16x32_bf16 v[92:95], a[92:95], a[60:63], v[92:95]
    v_exp_f32 v78, v78
    s_waitcnt lgkmcnt(4)
    v_mfma_f32_16x16x32_bf16 v[128:131], a[96:99], v[112:115], v[128:131]
    v_exp_f32 v80, v80
    v_mfma_f32_16x16x32_bf16 v[132:135], a[100:103], v[112:115], v[132:135]
    ds_read_b128 a[72:75], v20 offset:2048
    v_add_u32 v26, v26, v13
    v_mfma_f32_16x16x32_bf16 v[136:139], a[104:107], v[112:115], v[136:139]
    buffer_load_dwordx4 v21, s[80:83], s9 offen offset:2048 lds
    v_mfma_f32_16x16x32_bf16 v[140:143], a[108:111], v[112:115], v[140:143]
    v_exp_f32 v79, v79
    v_mfma_f32_16x16x32_bf16 v[144:147], a[112:115], v[112:115], v[144:147]
    buffer_load_dwordx4 v21, s[80:83], s9 offen offset:3072 lds
    v_mfma_f32_16x16x32_bf16 v[148:151], a[116:119], v[112:115], v[148:151]
    v_exp_f32 v81, v81
    v_mfma_f32_16x16x32_bf16 v[152:155], a[120:123], v[112:115], v[152:155]
    s_add_u32 s10, s10, 0x4000
    v_cvt_pk_bf16_f32 v119, v78, v79
    v_add_f32 v53, v53, v74
    v_mfma_f32_16x16x32_bf16 v[156:159], a[124:127], v[112:115], v[156:159]
    s_and_b32 m0, s10, 0x1ffff
    v_exp_f32 v82, v82
    s_waitcnt vmcnt(23)
    v_mfma_f32_16x16x32_bf16 a[176:179], a[200:203], a[128:131], a[176:179]
    s_add_u32 s9, s9, 0x2000
    buffer_load_dwordx4 a[128:131], v26, s[44:47], 0 offen offset:12
    v_mfma_f32_16x16x32_bf16 v[160:163], a[96:99], v[116:119], v[160:163]
    v_exp_f32 v83, v83
    v_mfma_f32_16x16x32_bf16 v[164:167], a[100:103], v[116:119], v[164:167]
    ds_read_b128 a[88:91], v20 offset:6144
    v_add_f32 v53, v53, v75
    v_mfma_f32_16x16x32_bf16 v[168:171], a[104:107], v[116:119], v[168:171]
    v_exp_f32 v84, v84
    v_mfma_f32_16x16x32_bf16 v[172:175], a[108:111], v[116:119], v[172:175]
    ds_read_b128 a[76:79], v20 offset:3072
    ds_read_b128 a[92:95], v20 offset:7168
    v_add_f32 v54, v54, v80
    v_mfma_f32_16x16x32_bf16 v[176:179], a[112:115], v[116:119], v[176:179]
    v_add_f32 v53, v53, v76
    v_add_f32 v54, v54, v81
    v_mfma_f32_16x16x32_bf16 v[180:183], a[116:119], v[116:119], v[180:183]
    v_add_u32 v27, v27, v13
    v_exp_f32 v85, v85
    s_waitcnt vmcnt(23)
    v_mfma_f32_16x16x32_bf16 a[176:179], a[204:207], a[132:135], a[176:179]
    buffer_load_dwordx4 a[132:135], v27, s[44:47], 0 offen offset:8
    v_add_f32 v53, v53, v77
    v_add_f32 v54, v54, v82
    v_mfma_f32_16x16x32_bf16 v[184:187], a[120:123], v[116:119], v[184:187]
    v_add_f32 v53, v53, v78
    v_add_f32 v53, v53, v79
    v_exp_f32 v86, v86
    v_mfma_f32_16x16x32_bf16 v[188:191], a[124:127], v[116:119], v[188:191]
    v_add_f32 v54, v54, v83
    v_add_f32 v54, v54, v84
    s_waitcnt lgkmcnt(0)
    v_mfma_f32_16x16x32_bf16 v[64:67], a[64:67], a[0:3], v[96:99]
    v_exp_f32 v87, v87
    v_mfma_f32_16x16x32_bf16 v[72:75], a[64:67], a[16:19], v[100:103]
    v_exp_f32 v88, v88
    v_mfma_f32_16x16x32_bf16 v[68:71], a[80:83], a[0:3], v[96:99]
    v_add_f32 v54, v54, v85
    v_add_u32 v28, v28, v13
    v_mfma_f32_16x16x32_bf16 v[76:79], a[80:83], a[16:19], v[100:103]
    v_exp_f32 v89, v89
    s_waitcnt vmcnt(23)
    v_mfma_f32_16x16x32_bf16 a[180:183], a[200:203], a[136:139], a[180:183]
    buffer_load_dwordx4 a[136:139], v28, s[44:47], 0 offen offset:4
    v_add_f32 v54, v54, v86
    v_mfma_f32_16x16x32_bf16 v[64:67], a[68:71], a[4:7], v[64:67]
    v_add_f32 v54, v54, v87
    v_cvt_pk_bf16_f32 v120, v80, v81
    v_mfma_f32_16x16x32_bf16 v[72:75], a[68:71], a[20:23], v[72:75]
    v_exp_f32 v90, v90
    v_mfma_f32_16x16x32_bf16 v[68:71], a[84:87], a[4:7], v[68:71]
    v_add_f32 v55, v55, v88
    v_cvt_pk_bf16_f32 v121, v82, v83
    v_mfma_f32_16x16x32_bf16 v[76:79], a[84:87], a[20:23], v[76:79]
    v_exp_f32 v91, v91
    v_mfma_f32_16x16x32_bf16 v[64:67], a[72:75], a[8:11], v[64:67]
    v_add_f32 v55, v55, v89
    v_add_u32 v29, v29, v13
    v_mfma_f32_16x16x32_bf16 v[72:75], a[72:75], a[24:27], v[72:75]
    v_exp_f32 v92, v92
    s_waitcnt vmcnt(23)
    v_mfma_f32_16x16x32_bf16 a[180:183], a[204:207], a[140:143], a[180:183]
    buffer_load_dwordx4 a[140:143], v29, s[44:47], 0 offen offset:0
    v_cvt_pk_bf16_f32 v122, v84, v85
    v_add_f32 v55, v55, v90
    v_mfma_f32_16x16x32_bf16 v[68:71], a[88:91], a[8:11], v[68:71]
    v_exp_f32 v93, v93
    v_mfma_f32_16x16x32_bf16 v[76:79], a[88:91], a[24:27], v[76:79]
    v_cvt_pk_bf16_f32 v123, v86, v87
    v_add_f32 v55, v55, v91
    v_mfma_f32_16x16x32_bf16 v[64:67], a[76:79], a[12:15], v[64:67]
    v_cvt_pk_bf16_f32 v124, v88, v89
    v_add_f32 v55, v55, v92
    v_mfma_f32_16x16x32_bf16 v[72:75], a[76:79], a[28:31], v[72:75]
    v_exp_f32 v94, v94
    v_exp_f32 v95, v95
    v_mfma_f32_16x16x32_bf16 v[68:71], a[92:95], a[12:15], v[68:71]
    v_cvt_pk_bf16_f32 v125, v90, v91
    v_add_f32 v55, v55, v93
    v_cvt_pk_bf16_f32 v126, v92, v93
    v_cvt_pk_bf16_f32 v127, v94, v95
    v_mfma_f32_16x16x32_bf16 v[76:79], a[92:95], a[28:31], v[76:79]
    v_add_u32 v20, 0x4000, v20
    v_add_f32 v55, v55, v94
    v_and_b32 v20, 0x1ffff, v20
    v_add_f32 v55, v55, v95
L_body_g1:
    s_waitcnt vmcnt(24)
    s_barrier
    v_mfma_f32_16x16x32_bf16 v[192:195], a[96:99], v[120:123], v[192:195]
    v_exp_f32 v64, v64
    v_mfma_f32_16x16x32_bf16 v[196:199], a[100:103], v[120:123], v[196:199]
    buffer_load_dwordx4 v21, s[80:83], s9 offen offset:0 lds
    v_mfma_f32_16x16x32_bf16 v[200:203], a[104:107], v[120:123], v[200:203]
    ds_read_b128 v[26:29], v14 offset:5760
    v_add_f32 v52, v52, v64
    v_mfma_f32_16x16x32_bf16 v[204:207], a[108:111], v[120:123], v[204:207]
    buffer_load_dwordx4 v21, s[80:83], s9 offen offset:1024 lds
    v_mfma_f32_16x16x32_bf16 v[208:211], a[112:115], v[120:123], v[208:211]
    v_exp_f32 v65, v65
    v_mfma_f32_16x16x32_bf16 v[212:215], a[116:119], v[120:123], v[212:215]
    v_exp_f32 v66, v66
    v_mfma_f32_16x16x32_bf16 v[216:219], a[120:123], v[120:123], v[216:219]
    v_exp_f32 v67, v67
    v_mfma_f32_16x16x32_bf16 v[220:223], a[124:127], v[120:123], v[220:223]
    v_exp_f32 v68, v68
    v_mfma_f32_16x16x32_bf16 v[224:227], a[96:99], v[124:127], v[224:227]
    ds_read_b128 a[96:99], v20 offset:8192
    v_add_f32 v52, v52, v65
    v_mfma_f32_16x16x32_bf16 v[228:231], a[100:103], v[124:127], v[228:231]
    ds_read_b128 a[100:103], v20 offset:9216
    v_cvt_pk_bf16_f32 v112, v64, v65
    v_mfma_f32_16x16x32_bf16 v[232:235], a[104:107], v[124:127], v[232:235]
    ds_read_b128 a[104:107], v20 offset:10240
    v_add_f32 v52, v52, v66
    v_mfma_f32_16x16x32_bf16 v[236:239], a[108:111], v[124:127], v[236:239]
    ds_read_b128 a[108:111], v20 offset:11264
    v_cvt_pk_bf16_f32 v113, v66, v67
    v_mfma_f32_16x16x32_bf16 v[240:243], a[112:115], v[124:127], v[240:243]
    v_exp_f32 v69, v69
    v_mfma_f32_16x16x32_bf16 v[244:247], a[116:119], v[124:127], v[244:247]
    ds_read_b128 a[112:115], v20 offset:12288
    v_add_f32 v52, v52, v67
    v_mfma_f32_16x16x32_bf16 v[248:251], a[120:123], v[124:127], v[248:251]
    v_exp_f32 v70, v70
    v_mfma_f32_16x16x32_bf16 v[252:255], a[124:127], v[124:127], v[252:255]
    ds_read_b128 a[116:119], v20 offset:13312
    v_cvt_pk_bf16_f32 v114, v68, v69
    v_mfma_f32_16x16x32_bf16 v[80:83], a[64:67], a[32:35], v[104:107]
    v_exp_f32 v71, v71
    v_mfma_f32_16x16x32_bf16 v[88:91], a[64:67], a[48:51], v[108:111]
    ds_read_b128 a[120:123], v20 offset:14336
    v_add_f32 v52, v52, v68
    v_mfma_f32_16x16x32_bf16 v[84:87], a[80:83], a[32:35], v[104:107]
    v_exp_f32 v72, v72
    v_mfma_f32_16x16x32_bf16 v[92:95], a[80:83], a[48:51], v[108:111]
    ds_read_b128 a[124:127], v20 offset:15360
    v_cvt_pk_bf16_f32 v115, v70, v71
    v_mfma_f32_16x16x32_bf16 v[80:83], a[68:71], a[36:39], v[80:83]
    v_exp_f32 v73, v73
    v_mfma_f32_16x16x32_bf16 v[88:91], a[68:71], a[52:55], v[88:91]
    v_exp_f32 v74, v74
    v_mfma_f32_16x16x32_bf16 v[84:87], a[84:87], a[36:39], v[84:87]
    ds_read_b128 a[64:67], v20 offset:0
    v_add_f32 v52, v52, v69
    v_mfma_f32_16x16x32_bf16 v[92:95], a[84:87], a[52:55], v[92:95]
    v_exp_f32 v75, v75
    v_mfma_f32_16x16x32_bf16 v[80:83], a[72:75], a[40:43], v[80:83]
    v_add_f32 v52, v52, v70
    v_cvt_pk_bf16_f32 v116, v72, v73
    v_mfma_f32_16x16x32_bf16 v[88:91], a[72:75], a[56:59], v[88:91]
    ds_read_b128 a[80:83], v20 offset:4096
    v_add_f32 v52, v52, v71
    v_mfma_f32_16x16x32_bf16 v[84:87], a[88:91], a[40:43], v[84:87]
    v_exp_f32 v76, v76
    v_mfma_f32_16x16x32_bf16 v[92:95], a[88:91], a[56:59], v[92:95]
    ds_read_b128 a[68:71], v20 offset:1024
    v_cvt_pk_bf16_f32 v117, v74, v75
    v_mfma_f32_16x16x32_bf16 v[80:83], a[76:79], a[44:47], v[80:83]
    v_exp_f32 v77, v77
    v_mfma_f32_16x16x32_bf16 v[88:91], a[76:79], a[60:63], v[88:91]
    v_add_f32 v53, v53, v72
    v_cvt_pk_bf16_f32 v118, v76, v77
    v_mfma_f32_16x16x32_bf16 v[84:87], a[92:95], a[44:47], v[84:87]
    ds_read_b128 a[84:87], v20 offset:5120
    v_add_f32 v53, v53, v73
    v_mfma_f32_16x16x32_bf16 v[92:95], a[92:95], a[60:63], v[92:95]
    v_exp_f32 v78, v78
    s_waitcnt lgkmcnt(4)
    v_mfma_f32_16x16x32_bf16 v[128:131], a[96:99], v[112:115], v[128:131]
    v_exp_f32 v80, v80
    v_mfma_f32_16x16x32_bf16 v[132:135], a[100:103], v[112:115], v[132:135]
    ds_read_b128 a[72:75], v20 offset:2048
    v_add_u32 v26, v26, v13
    v_mfma_f32_16x16x32_bf16 v[136:139], a[104:107], v[112:115], v[136:139]
    buffer_load_dwordx4 v21, s[80:83], s9 offen offset:2048 lds
    v_mfma_f32_16x16x32_bf16 v[140:143], a[108:111], v[112:115], v[140:143]
    v_exp_f32 v79, v79
    v_mfma_f32_16x16x32_bf16 v[144:147], a[112:115], v[112:115], v[144:147]
    buffer_load_dwordx4 v21, s[80:83], s9 offen offset:3072 lds
    v_mfma_f32_16x16x32_bf16 v[148:151], a[116:119], v[112:115], v[148:151]
    v_exp_f32 v81, v81
    v_mfma_f32_16x16x32_bf16 v[152:155], a[120:123], v[112:115], v[152:155]
    s_add_u32 s10, s10, 0x4000
    v_cvt_pk_bf16_f32 v119, v78, v79
    v_add_f32 v53, v53, v74
    v_mfma_f32_16x16x32_bf16 v[156:159], a[124:127], v[112:115], v[156:159]
    s_and_b32 m0, s10, 0x1ffff
    v_exp_f32 v82, v82
    s_waitcnt vmcnt(23)
    v_mfma_f32_16x16x32_bf16 a[184:187], a[200:203], a[144:147], a[184:187]
    s_add_u32 s9, s9, 0x2000
    buffer_load_dwordx4 a[144:147], v26, s[44:47], 0 offen offset:12
    v_mfma_f32_16x16x32_bf16 v[160:163], a[96:99], v[116:119], v[160:163]
    v_exp_f32 v83, v83
    v_mfma_f32_16x16x32_bf16 v[164:167], a[100:103], v[116:119], v[164:167]
    ds_read_b128 a[88:91], v20 offset:6144
    v_add_f32 v53, v53, v75
    v_mfma_f32_16x16x32_bf16 v[168:171], a[104:107], v[116:119], v[168:171]
    v_exp_f32 v84, v84
    v_mfma_f32_16x16x32_bf16 v[172:175], a[108:111], v[116:119], v[172:175]
    ds_read_b128 a[76:79], v20 offset:3072
    ds_read_b128 a[92:95], v20 offset:7168
    v_add_f32 v54, v54, v80
    v_mfma_f32_16x16x32_bf16 v[176:179], a[112:115], v[116:119], v[176:179]
    v_add_f32 v53, v53, v76
    v_add_f32 v54, v54, v81
    v_mfma_f32_16x16x32_bf16 v[180:183], a[116:119], v[116:119], v[180:183]
    v_add_u32 v27, v27, v13
    v_exp_f32 v85, v85
    s_waitcnt vmcnt(23)
    v_mfma_f32_16x16x32_bf16 a[184:187], a[204:207], a[148:151], a[184:187]
    buffer_load_dwordx4 a[148:151], v27, s[44:47], 0 offen offset:8
    v_add_f32 v53, v53, v77
    v_add_f32 v54, v54, v82
    v_mfma_f32_16x16x32_bf16 v[184:187], a[120:123], v[116:119], v[184:187]
    v_add_f32 v53, v53, v78
    v_add_f32 v53, v53, v79
    v_exp_f32 v86, v86
    v_mfma_f32_16x16x32_bf16 v[188:191], a[124:127], v[116:119], v[188:191]
    v_add_f32 v54, v54, v83
    v_add_f32 v54, v54, v84
    s_waitcnt lgkmcnt(0)
    v_mfma_f32_16x16x32_bf16 v[64:67], a[64:67], a[0:3], v[96:99]
    v_exp_f32 v87, v87
    v_mfma_f32_16x16x32_bf16 v[72:75], a[64:67], a[16:19], v[100:103]
    v_exp_f32 v88, v88
    v_mfma_f32_16x16x32_bf16 v[68:71], a[80:83], a[0:3], v[96:99]
    v_add_f32 v54, v54, v85
    v_add_u32 v28, v28, v13
    v_mfma_f32_16x16x32_bf16 v[76:79], a[80:83], a[16:19], v[100:103]
    v_exp_f32 v89, v89
    s_waitcnt vmcnt(23)
    v_mfma_f32_16x16x32_bf16 a[188:191], a[200:203], a[152:155], a[188:191]
    buffer_load_dwordx4 a[152:155], v28, s[44:47], 0 offen offset:4
    v_add_f32 v54, v54, v86
    v_mfma_f32_16x16x32_bf16 v[64:67], a[68:71], a[4:7], v[64:67]
    v_add_f32 v54, v54, v87
    v_cvt_pk_bf16_f32 v120, v80, v81
    v_mfma_f32_16x16x32_bf16 v[72:75], a[68:71], a[20:23], v[72:75]
    v_exp_f32 v90, v90
    v_mfma_f32_16x16x32_bf16 v[68:71], a[84:87], a[4:7], v[68:71]
    v_add_f32 v55, v55, v88
    v_cvt_pk_bf16_f32 v121, v82, v83
    v_mfma_f32_16x16x32_bf16 v[76:79], a[84:87], a[20:23], v[76:79]
    v_exp_f32 v91, v91
    v_mfma_f32_16x16x32_bf16 v[64:67], a[72:75], a[8:11], v[64:67]
    v_add_f32 v55, v55, v89
    v_add_u32 v29, v29, v13
    v_mfma_f32_16x16x32_bf16 v[72:75], a[72:75], a[24:27], v[72:75]
    v_exp_f32 v92, v92
    s_waitcnt vmcnt(23)
    v_mfma_f32_16x16x32_bf16 a[188:191], a[204:207], a[156:159], a[188:191]
    buffer_load_dwordx4 a[156:159], v29, s[44:47], 0 offen offset:0
    v_cvt_pk_bf16_f32 v122, v84, v85
    v_add_f32 v55, v55, v90
    v_mfma_f32_16x16x32_bf16 v[68:71], a[88:91], a[8:11], v[68:71]
    v_exp_f32 v93, v93
    v_mfma_f32_16x16x32_bf16 v[76:79], a[88:91], a[24:27], v[76:79]
    v_cvt_pk_bf16_f32 v123, v86, v87
    v_add_f32 v55, v55, v91
    v_mfma_f32_16x16x32_bf16 v[64:67], a[76:79], a[12:15], v[64:67]
    v_cvt_pk_bf16_f32 v124, v88, v89
    v_add_f32 v55, v55, v92
    v_mfma_f32_16x16x32_bf16 v[72:75], a[76:79], a[28:31], v[72:75]
    v_exp_f32 v94, v94
    v_exp_f32 v95, v95
    v_mfma_f32_16x16x32_bf16 v[68:71], a[92:95], a[12:15], v[68:71]
    v_cvt_pk_bf16_f32 v125, v90, v91
    v_add_f32 v55, v55, v93
    v_cvt_pk_bf16_f32 v126, v92, v93
    v_cvt_pk_bf16_f32 v127, v94, v95
    v_mfma_f32_16x16x32_bf16 v[76:79], a[92:95], a[28:31], v[76:79]
    v_add_u32 v20, 0x4000, v20
    v_add_f32 v55, v55, v94
    v_and_b32 v20, 0x1ffff, v20
    v_add_f32 v55, v55, v95
L_body_g2:
    s_waitcnt vmcnt(24)
    s_barrier
    v_mfma_f32_16x16x32_bf16 v[192:195], a[96:99], v[120:123], v[192:195]
    v_exp_f32 v64, v64
    v_mfma_f32_16x16x32_bf16 v[196:199], a[100:103], v[120:123], v[196:199]
    buffer_load_dwordx4 v21, s[80:83], s9 offen offset:0 lds
    v_mfma_f32_16x16x32_bf16 v[200:203], a[104:107], v[120:123], v[200:203]
    ds_read_b128 v[26:29], v14 offset:11136
    v_add_f32 v52, v52, v64
    v_mfma_f32_16x16x32_bf16 v[204:207], a[108:111], v[120:123], v[204:207]
    buffer_load_dwordx4 v21, s[80:83], s9 offen offset:1024 lds
    v_mfma_f32_16x16x32_bf16 v[208:211], a[112:115], v[120:123], v[208:211]
    v_exp_f32 v65, v65
    v_mfma_f32_16x16x32_bf16 v[212:215], a[116:119], v[120:123], v[212:215]
    v_exp_f32 v66, v66
    v_mfma_f32_16x16x32_bf16 v[216:219], a[120:123], v[120:123], v[216:219]
    v_exp_f32 v67, v67
    v_mfma_f32_16x16x32_bf16 v[220:223], a[124:127], v[120:123], v[220:223]
    v_exp_f32 v68, v68
    v_mfma_f32_16x16x32_bf16 v[224:227], a[96:99], v[124:127], v[224:227]
    ds_read_b128 a[96:99], v20 offset:8192
    v_add_f32 v52, v52, v65
    v_mfma_f32_16x16x32_bf16 v[228:231], a[100:103], v[124:127], v[228:231]
    ds_read_b128 a[100:103], v20 offset:9216
    v_cvt_pk_bf16_f32 v112, v64, v65
    v_mfma_f32_16x16x32_bf16 v[232:235], a[104:107], v[124:127], v[232:235]
    ds_read_b128 a[104:107], v20 offset:10240
    v_add_f32 v52, v52, v66
    v_mfma_f32_16x16x32_bf16 v[236:239], a[108:111], v[124:127], v[236:239]
    ds_read_b128 a[108:111], v20 offset:11264
    v_cvt_pk_bf16_f32 v113, v66, v67
    v_mfma_f32_16x16x32_bf16 v[240:243], a[112:115], v[124:127], v[240:243]
    v_exp_f32 v69, v69
    v_mfma_f32_16x16x32_bf16 v[244:247], a[116:119], v[124:127], v[244:247]
    ds_read_b128 a[112:115], v20 offset:12288
    v_add_f32 v52, v52, v67
    v_mfma_f32_16x16x32_bf16 v[248:251], a[120:123], v[124:127], v[248:251]
    v_exp_f32 v70, v70
    v_mfma_f32_16x16x32_bf16 v[252:255], a[124:127], v[124:127], v[252:255]
    ds_read_b128 a[116:119], v20 offset:13312
    v_cvt_pk_bf16_f32 v114, v68, v69
    v_mfma_f32_16x16x32_bf16 v[80:83], a[64:67], a[32:35], v[104:107]
    v_exp_f32 v71, v71
    v_mfma_f32_16x16x32_bf16 v[88:91], a[64:67], a[48:51], v[108:111]
    ds_read_b128 a[120:123], v20 offset:14336
    v_add_f32 v52, v52, v68
    v_mfma_f32_16x16x32_bf16 v[84:87], a[80:83], a[32:35], v[104:107]
    v_exp_f32 v72, v72
    v_mfma_f32_16x16x32_bf16 v[92:95], a[80:83], a[48:51], v[108:111]
    ds_read_b128 a[124:127], v20 offset:15360
    v_cvt_pk_bf16_f32 v115, v70, v71
    v_mfma_f32_16x16x32_bf16 v[80:83], a[68:71], a[36:39], v[80:83]
    v_exp_f32 v73, v73
    v_mfma_f32_16x16x32_bf16 v[88:91], a[68:71], a[52:55], v[88:91]
    v_exp_f32 v74, v74
    v_mfma_f32_16x16x32_bf16 v[84:87], a[84:87], a[36:39], v[84:87]
    ds_read_b128 a[64:67], v20 offset:0
    v_add_f32 v52, v52, v69
    v_mfma_f32_16x16x32_bf16 v[92:95], a[84:87], a[52:55], v[92:95]
    v_exp_f32 v75, v75
    v_mfma_f32_16x16x32_bf16 v[80:83], a[72:75], a[40:43], v[80:83]
    v_add_f32 v52, v52, v70
    v_cvt_pk_bf16_f32 v116, v72, v73
    v_mfma_f32_16x16x32_bf16 v[88:91], a[72:75], a[56:59], v[88:91]
    ds_read_b128 a[80:83], v20 offset:4096
    v_add_f32 v52, v52, v71
    v_mfma_f32_16x16x32_bf16 v[84:87], a[88:91], a[40:43], v[84:87]
    v_exp_f32 v76, v76
    v_mfma_f32_16x16x32_bf16 v[92:95], a[88:91], a[56:59], v[92:95]
    ds_read_b128 a[68:71], v20 offset:1024
    v_cvt_pk_bf16_f32 v117, v74, v75
    v_mfma_f32_16x16x32_bf16 v[80:83], a[76:79], a[44:47], v[80:83]
    v_exp_f32 v77, v77
    v_mfma_f32_16x16x32_bf16 v[88:91], a[76:79], a[60:63], v[88:91]
    v_add_f32 v53, v53, v72
    v_cvt_pk_bf16_f32 v118, v76, v77
    v_mfma_f32_16x16x32_bf16 v[84:87], a[92:95], a[44:47], v[84:87]
    ds_read_b128 a[84:87], v20 offset:5120
    v_add_f32 v53, v53, v73
    v_mfma_f32_16x16x32_bf16 v[92:95], a[92:95], a[60:63], v[92:95]
    v_exp_f32 v78, v78
    s_waitcnt lgkmcnt(4)
    v_mfma_f32_16x16x32_bf16 v[128:131], a[96:99], v[112:115], v[128:131]
    v_exp_f32 v80, v80
    v_mfma_f32_16x16x32_bf16 v[132:135], a[100:103], v[112:115], v[132:135]
    ds_read_b128 a[72:75], v20 offset:2048
    v_add_u32 v26, v26, v13
    v_mfma_f32_16x16x32_bf16 v[136:139], a[104:107], v[112:115], v[136:139]
    buffer_load_dwordx4 v21, s[80:83], s9 offen offset:2048 lds
    v_mfma_f32_16x16x32_bf16 v[140:143], a[108:111], v[112:115], v[140:143]
    v_exp_f32 v79, v79
    v_mfma_f32_16x16x32_bf16 v[144:147], a[112:115], v[112:115], v[144:147]
    buffer_load_dwordx4 v21, s[80:83], s9 offen offset:3072 lds
    v_mfma_f32_16x16x32_bf16 v[148:151], a[116:119], v[112:115], v[148:151]
    v_exp_f32 v81, v81
    v_mfma_f32_16x16x32_bf16 v[152:155], a[120:123], v[112:115], v[152:155]
    s_add_u32 s10, s10, 0x4000
    v_cvt_pk_bf16_f32 v119, v78, v79
    v_add_f32 v53, v53, v74
    v_mfma_f32_16x16x32_bf16 v[156:159], a[124:127], v[112:115], v[156:159]
    s_and_b32 m0, s10, 0x1ffff
    v_exp_f32 v82, v82
    s_waitcnt vmcnt(23)
    v_mfma_f32_16x16x32_bf16 a[192:195], a[200:203], a[160:163], a[192:195]
    s_add_u32 s9, s9, 0x2000
    buffer_load_dwordx4 a[160:163], v26, s[44:47], 0 offen offset:12
    v_mfma_f32_16x16x32_bf16 v[160:163], a[96:99], v[116:119], v[160:163]
    s_sub_u32 s11, s11, 1
    v_exp_f32 v83, v83
    v_mfma_f32_16x16x32_bf16 v[164:167], a[100:103], v[116:119], v[164:167]
    ds_read_b128 a[88:91], v20 offset:6144
    v_add_f32 v53, v53, v75
    v_mfma_f32_16x16x32_bf16 v[168:171], a[104:107], v[116:119], v[168:171]
    v_exp_f32 v84, v84
    v_mfma_f32_16x16x32_bf16 v[172:175], a[108:111], v[116:119], v[172:175]
    ds_read_b128 a[76:79], v20 offset:3072
    ds_read_b128 a[92:95], v20 offset:7168
    v_add_f32 v54, v54, v80
    v_mfma_f32_16x16x32_bf16 v[176:179], a[112:115], v[116:119], v[176:179]
    v_add_f32 v53, v53, v76
    v_add_f32 v54, v54, v81
    v_mfma_f32_16x16x32_bf16 v[180:183], a[116:119], v[116:119], v[180:183]
    v_add_u32 v27, v27, v13
    v_exp_f32 v85, v85
    s_waitcnt vmcnt(23)
    v_mfma_f32_16x16x32_bf16 a[192:195], a[204:207], a[164:167], a[192:195]
    buffer_load_dwordx4 a[164:167], v27, s[44:47], 0 offen offset:8
    v_add_f32 v53, v53, v77
    v_add_f32 v54, v54, v82
    v_mfma_f32_16x16x32_bf16 v[184:187], a[120:123], v[116:119], v[184:187]
    v_add_f32 v53, v53, v78
    v_add_f32 v53, v53, v79
    v_exp_f32 v86, v86
    v_mfma_f32_16x16x32_bf16 v[188:191], a[124:127], v[116:119], v[188:191]
    v_add_f32 v54, v54, v83
    v_add_f32 v54, v54, v84
    s_waitcnt lgkmcnt(0)
    v_mfma_f32_16x16x32_bf16 v[64:67], a[64:67], a[0:3], v[96:99]
    v_exp_f32 v87, v87
    v_mfma_f32_16x16x32_bf16 v[72:75], a[64:67], a[16:19], v[100:103]
    v_exp_f32 v88, v88
    v_mfma_f32_16x16x32_bf16 v[68:71], a[80:83], a[0:3], v[96:99]
    v_add_f32 v54, v54, v85
    v_add_u32 v28, v28, v13
    v_mfma_f32_16x16x32_bf16 v[76:79], a[80:83], a[16:19], v[100:103]
    v_exp_f32 v89, v89
    s_waitcnt vmcnt(23)
    v_mfma_f32_16x16x32_bf16 a[196:199], a[200:203], a[168:171], a[196:199]
    buffer_load_dwordx4 a[168:171], v28, s[44:47], 0 offen offset:4
    v_add_f32 v54, v54, v86
    v_mfma_f32_16x16x32_bf16 v[64:67], a[68:71], a[4:7], v[64:67]
    v_add_f32 v54, v54, v87
    v_cvt_pk_bf16_f32 v120, v80, v81
    v_mfma_f32_16x16x32_bf16 v[72:75], a[68:71], a[20:23], v[72:75]
    v_exp_f32 v90, v90
    v_mfma_f32_16x16x32_bf16 v[68:71], a[84:87], a[4:7], v[68:71]
    v_add_f32 v55, v55, v88
    v_cvt_pk_bf16_f32 v121, v82, v83
    v_mfma_f32_16x16x32_bf16 v[76:79], a[84:87], a[20:23], v[76:79]
    v_exp_f32 v91, v91
    v_mfma_f32_16x16x32_bf16 v[64:67], a[72:75], a[8:11], v[64:67]
    v_add_f32 v55, v55, v89
    v_add_u32 v29, v29, v13
    v_mfma_f32_16x16x32_bf16 v[72:75], a[72:75], a[24:27], v[72:75]
    v_exp_f32 v92, v92
    s_waitcnt vmcnt(23)
    v_mfma_f32_16x16x32_bf16 a[196:199], a[204:207], a[172:175], a[196:199]
    buffer_load_dwordx4 a[172:175], v29, s[44:47], 0 offen offset:0
    v_cvt_pk_bf16_f32 v122, v84, v85
    v_add_f32 v55, v55, v90
    v_mfma_f32_16x16x32_bf16 v[68:71], a[88:91], a[8:11], v[68:71]
    v_exp_f32 v93, v93
    v_mfma_f32_16x16x32_bf16 v[76:79], a[88:91], a[24:27], v[76:79]
    v_cvt_pk_bf16_f32 v123, v86, v87
    v_add_f32 v55, v55, v91
    v_mfma_f32_16x16x32_bf16 v[64:67], a[76:79], a[12:15], v[64:67]
    v_cvt_pk_bf16_f32 v124, v88, v89
    v_add_f32 v55, v55, v92
    v_mfma_f32_16x16x32_bf16 v[72:75], a[76:79], a[28:31], v[72:75]
    v_exp_f32 v94, v94
    v_exp_f32 v95, v95
    v_mfma_f32_16x16x32_bf16 v[68:71], a[92:95], a[12:15], v[68:71]
    s_cmp_lg_u32 s11, 0
    v_cvt_pk_bf16_f32 v125, v90, v91
    v_add_f32 v55, v55, v93
    v_cvt_pk_bf16_f32 v126, v92, v93
    v_cvt_pk_bf16_f32 v127, v94, v95
    v_mfma_f32_16x16x32_bf16 v[76:79], a[92:95], a[28:31], v[76:79]
    v_add_u32 v20, 0x4000, v20
    v_add_f32 v55, v55, v94
    v_add_u32 v14, 256, v14
    v_and_b32 v20, 0x1ffff, v20
    v_add_f32 v55, v55, v95
    s_cbranch_scc1 L_body_g0
    s_mov_b32 s11, s17
    s_cmp_lg_u32 s17, 0
    s_cbranch_scc1 L_body_m
L_loop_done:
L_body_lf:
    s_waitcnt vmcnt(12)
    s_barrier
    v_mfma_f32_16x16x32_bf16 v[192:195], a[96:99], v[120:123], v[192:195]
    v_exp_f32 v64, v64
    v_mfma_f32_16x16x32_bf16 v[196:199], a[100:103], v[120:123], v[196:199]
    v_exp_f32 v65, v65
    v_mfma_f32_16x16x32_bf16 v[200:203], a[104:107], v[120:123], v[200:203]
    v_exp_f32 v66, v66
    v_mfma_f32_16x16x32_bf16 v[204:207], a[108:111], v[120:123], v[204:207]
    v_exp_f32 v67, v67
    v_mfma_f32_16x16x32_bf16 v[208:211], a[112:115], v[120:123], v[208:211]
    v_add_f32 v52, v52, v64
    v_add_f32 v52, v52, v65
    v_mfma_f32_16x16x32_bf16 v[212:215], a[116:119], v[120:123], v[212:215]
    v_exp_f32 v68, v68
    v_mfma_f32_16x16x32_bf16 v[216:219], a[120:123], v[120:123], v[216:219]
    v_exp_f32 v69, v69
    v_mfma_f32_16x16x32_bf16 v[220:223], a[124:127], v[120:123], v[220:223]
    v_add_f32 v52, v52, v66
    v_cvt_pk_bf16_f32 v112, v64, v65
    v_mfma_f32_16x16x32_bf16 v[224:227], a[96:99], v[124:127], v[224:227]
    ds_read_b128 a[96:99], v20 offset:8192
    v_add_f32 v52, v52, v67
    v_mfma_f32_16x16x32_bf16 v[228:231], a[100:103], v[124:127], v[228:231]
    ds_read_b128 a[100:103], v20 offset:9216
    v_cvt_pk_bf16_f32 v113, v66, v67
    v_mfma_f32_16x16x32_bf16 v[232:235], a[104:107], v[124:127], v[232:235]
    ds_read_b128 a[104:107], v20 offset:10240
    v_add_f32 v52, v52, v68
    v_mfma_f32_16x16x32_bf16 v[236:239], a[108:111], v[124:127], v[236:239]
    ds_read_b128 a[108:111], v20 offset:11264
    v_cvt_pk_bf16_f32 v114, v68, v69
    v_mfma_f32_16x16x32_bf16 v[240:243], a[112:115], v[124:127], v[240:243]
    ds_read_b128 a[112:115], v20 offset:12288
    v_add_f32 v52, v52, v69
    v_mfma_f32_16x16x32_bf16 v[244:247], a[116:119], v[124:127], v[244:247]
    v_exp_f32 v70, v70
    v_mfma_f32_16x16x32_bf16 v[248:251], a[120:123], v[124:127], v[248:251]
    ds_read_b128 a[116:119], v20 offset:13312
    v_add_f32 v52, v52, v70
    v_mfma_f32_16x16x32_bf16 v[252:255], a[124:127], v[124:127], v[252:255]
    v_exp_f32 v71, v71
    v_mfma_f32_16x16x32_bf16 v[80:83], a[64:67], a[32:35], v[104:107]
    ds_read_b128 a[120:123], v20 offset:14336
    v_cvt_pk_bf16_f32 v115, v70, v71
    v_mfma_f32_16x16x32_bf16 v[88:91], a[64:67], a[48:51], v[108:111]
    ds_read_b128 a[124:127], v20 offset:15360
    v_add_f32 v52, v52, v71
    v_mfma_f32_16x16x32_bf16 v[84:87], a[80:83], a[32:35], v[104:107]
    v_exp_f32 v72, v72
    v_mfma_f32_16x16x32_bf16 v[92:95], a[80:83], a[48:51], v[108:111]
    v_exp_f32 v73, v73
    v_mfma_f32_16x16x32_bf16 v[80:83], a[68:71], a[36:39], v[80:83]
    v_exp_f32 v74, v74
    v_mfma_f32_16x16x32_bf16 v[88:91], a[68:71], a[52:55], v[88:91]
    v_cvt_pk_bf16_f32 v116, v72, v73
    v_add_f32 v53, v53, v72
    v_mfma_f32_16x16x32_bf16 v[84:87], a[84:87], a[36:39], v[84:87]
    v_exp_f32 v75, v75
    v_mfma_f32_16x16x32_bf16 v[92:95], a[84:87], a[52:55], v[92:95]
    v_cvt_pk_bf16_f32 v117, v74, v75
    v_add_f32 v53, v53, v73
    v_mfma_f32_16x16x32_bf16 v[80:83], a[72:75], a[40:43], v[80:83]
    v_exp_f32 v76, v76
    v_mfma_f32_16x16x32_bf16 v[88:91], a[72:75], a[56:59], v[88:91]
    v_exp_f32 v77, v77
    v_mfma_f32_16x16x32_bf16 v[84:87], a[88:91], a[40:43], v[84:87]
    v_cvt_pk_bf16_f32 v118, v76, v77
    v_add_f32 v53, v53, v74
    v_mfma_f32_16x16x32_bf16 v[92:95], a[88:91], a[56:59], v[92:95]
    v_exp_f32 v78, v78
    v_mfma_f32_16x16x32_bf16 v[80:83], a[76:79], a[44:47], v[80:83]
    v_add_f32 v53, v53, v75
    v_add_f32 v53, v53, v76
    v_mfma_f32_16x16x32_bf16 v[88:91], a[76:79], a[60:63], v[88:91]
    v_exp_f32 v79, v79
    v_mfma_f32_16x16x32_bf16 v[84:87], a[92:95], a[44:47], v[84:87]
    v_cvt_pk_bf16_f32 v119, v78, v79
    v_add_f32 v53, v53, v77
    v_mfma_f32_16x16x32_bf16 v[92:95], a[92:95], a[60:63], v[92:95]
    v_add_f32 v53, v53, v78
    v_add_f32 v53, v53, v79
    s_waitcnt lgkmcnt(0)
    v_mfma_f32_16x16x32_bf16 v[128:131], a[96:99], v[112:115], v[128:131]
    v_exp_f32 v80, v80
    v_mfma_f32_16x16x32_bf16 v[132:135], a[100:103], v[112:115], v[132:135]
    v_exp_f32 v81, v81
    v_mfma_f32_16x16x32_bf16 v[136:139], a[104:107], v[112:115], v[136:139]
    v_exp_f32 v82, v82
    v_mfma_f32_16x16x32_bf16 v[140:143], a[108:111], v[112:115], v[140:143]
    v_exp_f32 v83, v83
    v_mfma_f32_16x16x32_bf16 v[144:147], a[112:115], v[112:115], v[144:147]
    v_exp_f32 v84, v84
    v_mfma_f32_16x16x32_bf16 v[148:151], a[116:119], v[112:115], v[148:151]
    v_exp_f32 v85, v85
    v_mfma_f32_16x16x32_bf16 v[152:155], a[120:123], v[112:115], v[152:155]
    v_exp_f32 v86, v86
    v_mfma_f32_16x16x32_bf16 v[156:159], a[124:127], v[112:115], v[156:159]
    v_exp_f32 v87, v87
    v_mfma_f32_16x16x32_bf16 v[160:163], a[96:99], v[116:119], v[160:163]
    v_add_f32 v54, v54, v80
    v_add_f32 v54, v54, v81
    v_mfma_f32_16x16x32_bf16 v[164:167], a[100:103], v[116:119], v[164:167]
    v_exp_f32 v88, v88
    v_mfma_f32_16x16x32_bf16 v[168:171], a[104:107], v[116:119], v[168:171]
    v_add_f32 v54, v54, v82
    v_add_f32 v54, v54, v83
    v_mfma_f32_16x16x32_bf16 v[172:175], a[108:111], v[116:119], v[172:175]
    v_exp_f32 v89, v89
    v_mfma_f32_16x16x32_bf16 v[176:179], a[112:115], v[116:119], v[176:179]
    v_exp_f32 v90, v90
    v_mfma_f32_16x16x32_bf16 v[180:183], a[116:119], v[116:119], v[180:183]
    v_add_f32 v54, v54, v84
    v_add_f32 v54, v54, v85
    v_exp_f32 v91, v91
    v_exp_f32 v92, v92
    v_exp_f32 v93, v93
    v_exp_f32 v94, v94
    v_exp_f32 v95, v95
    v_mfma_f32_16x16x32_bf16 v[184:187], a[120:123], v[116:119], v[184:187]
    v_add_f32 v54, v54, v86
    v_add_f32 v54, v54, v87
    v_cvt_pk_bf16_f32 v120, v80, v81
    v_cvt_pk_bf16_f32 v121, v82, v83
    v_cvt_pk_bf16_f32 v122, v84, v85
    v_cvt_pk_bf16_f32 v123, v86, v87
    v_cvt_pk_bf16_f32 v124, v88, v89
    v_cvt_pk_bf16_f32 v125, v90, v91
    v_cvt_pk_bf16_f32 v126, v92, v93
    v_cvt_pk_bf16_f32 v127, v94, v95
    v_mfma_f32_16x16x32_bf16 v[188:191], a[124:127], v[116:119], v[188:191]
    v_add_f32 v55, v55, v88
    v_add_f32 v55, v55, v89
    v_add_f32 v55, v55, v90
    v_add_f32 v55, v55, v91
    v_add_f32 v55, v55, v92
    v_add_f32 v55, v55, v93
    v_add_f32 v55, v55, v94
    v_add_f32 v55, v55, v95
    s_nop 1
    v_mfma_f32_16x16x32_bf16 v[192:195], a[96:99], v[120:123], v[192:195]
    v_cvt_pk_bf16_f32 v26, v128, v129
    v_cvt_pk_bf16_f32 v27, v130, v131
    v_mfma_f32_16x16x32_bf16 v[196:199], a[100:103], v[120:123], v[196:199]
    v_cvt_pk_bf16_f32 v28, v132, v133
    v_cvt_pk_bf16_f32 v29, v134, v135
    buffer_store_dwordx4 v[26:29], v21, s[4:7], s56 offen offset:0 sc1
    v_mfma_f32_16x16x32_bf16 v[200:203], a[104:107], v[120:123], v[200:203]
    v_cvt_pk_bf16_f32 v30, v136, v137
    v_cvt_pk_bf16_f32 v31, v138, v139
    v_mfma_f32_16x16x32_bf16 v[204:207], a[108:111], v[120:123], v[204:207]
    v_cvt_pk_bf16_f32 v32, v140, v141
    v_cvt_pk_bf16_f32 v33, v142, v143
    buffer_store_dwordx4 v[30:33], v21, s[4:7], s56 offen offset:1024 sc1
    v_mfma_f32_16x16x32_bf16 v[208:211], a[112:115], v[120:123], v[208:211]
    v_cvt_pk_bf16_f32 v26, v144, v145
    v_cvt_pk_bf16_f32 v27, v146, v147
    v_mfma_f32_16x16x32_bf16 v[212:215], a[116:119], v[120:123], v[212:215]
    v_cvt_pk_bf16_f32 v28, v148, v149
    v_cvt_pk_bf16_f32 v29, v150, v151
    buffer_store_dwordx4 v[26:29], v21, s[4:7], s56 offen offset:2048 sc1
    v_mfma_f32_16x16x32_bf16 v[216:219], a[120:123], v[120:123], v[216:219]
    v_cvt_pk_bf16_f32 v30, v152, v153
    v_cvt_pk_bf16_f32 v31, v154, v155
    v_mfma_f32_16x16x32_bf16 v[220:223], a[124:127], v[120:123], v[220:223]
    v_cvt_pk_bf16_f32 v32, v156, v157
    v_cvt_pk_bf16_f32 v33, v158, v159
    buffer_store_dwordx4 v[30:33], v21, s[4:7], s56 offen offset:3072 sc1
    v_mfma_f32_16x16x32_bf16 v[224:227], a[96:99], v[124:127], v[224:227]
    v_cvt_pk_bf16_f32 v26, v160, v161
    v_cvt_pk_bf16_f32 v27, v162, v163
    v_mfma_f32_16x16x32_bf16 v[228:231], a[100:103], v[124:127], v[228:231]
    v_cvt_pk_bf16_f32 v28, v164, v165
    v_cvt_pk_bf16_f32 v29, v166, v167
    buffer_store_dwordx4 v[26:29], v21, s[4:7], s57 offen offset:0 sc1
    v_mfma_f32_16x16x32_bf16 v[232:235], a[104:107], v[124:127], v[232:235]
    v_cvt_pk_bf16_f32 v30, v168, v169
    v_cvt_pk_bf16_f32 v31, v170, v171
    v_mfma_f32_16x16x32_bf16 v[236:239], a[108:111], v[124:127], v[236:239]
    v_cvt_pk_bf16_f32 v32, v172, v173
    v_cvt_pk_bf16_f32 v33, v174, v175
    buffer_store_dwordx4 v[30:33], v21, s[4:7], s57 offen offset:1024 sc1
    v_mfma_f32_16x16x32_bf16 v[240:243], a[112:115], v[124:127], v[240:243]
    v_cvt_pk_bf16_f32 v26, v176, v177
    v_cvt_pk_bf16_f32 v27, v178, v179
    v_mfma_f32_16x16x32_bf16 v[244:247], a[116:119], v[124:127], v[244:247]
    v_cvt_pk_bf16_f32 v28, v180, v181
    v_cvt_pk_bf16_f32 v29, v182, v183
    buffer_store_dwordx4 v[26:29], v21, s[4:7], s57 offen offset:2048 sc1
    v_mfma_f32_16x16x32_bf16 v[248:251], a[120:123], v[124:127], v[248:251]
    v_cvt_pk_bf16_f32 v30, v184, v185
    v_cvt_pk_bf16_f32 v31, v186, v187
    v_mfma_f32_16x16x32_bf16 v[252:255], a[124:127], v[124:127], v[252:255]
    v_cvt_pk_bf16_f32 v32, v188, v189
    v_cvt_pk_bf16_f32 v33, v190, v191
    buffer_store_dwordx4 v[30:33], v21, s[4:7], s57 offen offset:3072 sc1
L_k2_chk:
    v_cvt_pk_bf16_f32 v26, v192, v193
    v_cvt_pk_bf16_f32 v27, v194, v195
    v_cvt_pk_bf16_f32 v28, v196, v197
    v_cvt_pk_bf16_f32 v29, v198, v199
    buffer_store_dwordx4 v[26:29], v21, s[4:7], s58 offen offset:0 sc1
    v_cvt_pk_bf16_f32 v30, v200, v201
    v_cvt_pk_bf16_f32 v31, v202, v203
    v_cvt_pk_bf16_f32 v32, v204, v205
    v_cvt_pk_bf16_f32 v33, v206, v207
    buffer_store_dwordx4 v[30:33], v21, s[4:7], s58 offen offset:1024 sc1
    v_cvt_pk_bf16_f32 v26, v208, v209
    v_cvt_pk_bf16_f32 v27, v210, v211
    v_cvt_pk_bf16_f32 v28, v212, v213
    v_cvt_pk_bf16_f32 v29, v214, v215
    buffer_store_dwordx4 v[26:29], v21, s[4:7], s58 offen offset:2048 sc1
    v_cvt_pk_bf16_f32 v30, v216, v217
    v_cvt_pk_bf16_f32 v31, v218, v219
    v_cvt_pk_bf16_f32 v32, v220, v221
    v_cvt_pk_bf16_f32 v33, v222, v223
    buffer_store_dwordx4 v[30:33], v21, s[4:7], s58 offen offset:3072 sc1
    v_cvt_pk_bf16_f32 v26, v224, v225
    v_cvt_pk_bf16_f32 v27, v226, v227
    v_cvt_pk_bf16_f32 v28, v228, v229
    v_cvt_pk_bf16_f32 v29, v230, v231
    buffer_store_dwordx4 v[26:29], v21, s[4:7], s59 offen offset:0 sc1
    v_cvt_pk_bf16_f32 v30, v232, v233
    v_cvt_pk_bf16_f32 v31, v234, v235
    v_cvt_pk_bf16_f32 v32, v236, v237
    v_cvt_pk_bf16_f32 v33, v238, v239
    buffer_store_dwordx4 v[30:33], v21, s[4:7], s59 offen offset:1024 sc1
    v_cvt_pk_bf16_f32 v26, v240, v241
    v_cvt_pk_bf16_f32 v27, v242, v243
    v_cvt_pk_bf16_f32 v28, v244, v245
    v_cvt_pk_bf16_f32 v29, v246, v247
    buffer_store_dwordx4 v[26:29], v21, s[4:7], s59 offen offset:2048 sc1
    v_cvt_pk_bf16_f32 v30, v248, v249
    v_cvt_pk_bf16_f32 v31, v250, v251
    v_cvt_pk_bf16_f32 v32, v252, v253
    v_cvt_pk_bf16_f32 v33, v254, v255
    buffer_store_dwordx4 v[30:33], v21, s[4:7], s59 offen offset:3072 sc1
    v_max3_f32 v4, v52, v53, v54
    v_max_f32 v4, v4, v55
    v_add_f32 v6, v52, v53
    v_add_f32 v7, v54, v55
    v_add_f32 v6, v6, v7
    s_mov_b32 s15, 0x53800000
    v_cmp_ngt_f32 vcc, s15, v4
    v_cmp_u_f32 s[64:65], v6, v6
    v_mov_b32 v5, 131072
    v_mov_b32 v4, 1
    s_or_b64 vcc, vcc, s[64:65]
    s_cbranch_vccz L_k2_chk2
    ds_write_b32 v5, v4
L_k2_chk2:
    v_and_b32 v8, 15, v0
    v_lshlrev_b32 v8, 3, v8
    v_mov_b32 v42, v52
    v_mov_b32 v43, v53
    v_mov_b32 v44, v54
    v_mov_b32 v45, v55
    s_nop 0
    v_permlane32_swap_b32 v52, v42
    v_permlane32_swap_b32 v53, v43
    v_permlane32_swap_b32 v54, v44
    v_permlane32_swap_b32 v55, v45
    s_nop 0
    v_add_f32 v52, v52, v42
    v_add_f32 v53, v53, v43
    v_add_f32 v54, v54, v44
    v_add_f32 v55, v55, v45
    v_mov_b32 v42, v52
    v_mov_b32 v43, v53
    v_mov_b32 v44, v54
    v_mov_b32 v45, v55
    s_nop 0
    v_permlane16_swap_b32 v52, v42
    v_permlane16_swap_b32 v53, v43
    v_permlane16_swap_b32 v54, v44
    v_permlane16_swap_b32 v55, v45
    s_nop 0
    v_add_f32 v57, v52, v42
    v_add_f32 v59, v53, v43
    v_add_f32 v61, v54, v44
    v_add_f32 v63, v55, v45
    v_sub_f32 v56, 0, v96
    v_sub_f32 v58, 0, v100
    v_sub_f32 v60, 0, v104
    v_sub_f32 v62, 0, v108
    s_mov_b64 exec, 0xffff
    buffer_store_dwordx2 v[56:57], v8, s[4:7], s25 offen offset:0 sc1
    buffer_store_dwordx2 v[58:59], v8, s[4:7], s25 offen offset:128 sc1
    buffer_store_dwordx2 v[60:61], v8, s[4:7], s25 offen offset:256 sc1
    buffer_store_dwordx2 v[62:63], v8, s[4:7], s25 offen offset:384 sc1
    s_mov_b64 exec, -1
    s_waitcnt vmcnt(20) lgkmcnt(0)
    s_lshl_b32 s52, s8, 13
    s_add_u32 s52, s52, 15728640
    s_add_u32 s16, s52, 4096
    buffer_load_dwordx4 a[224:227], v21, s[4:7], s52 offen offset:0
    buffer_load_dwordx4 a[228:231], v21, s[4:7], s52 offen offset:1024
    buffer_load_dwordx4 a[232:235], v21, s[4:7], s52 offen offset:2048
    buffer_load_dwordx4 a[236:239], v21, s[4:7], s52 offen offset:3072
    buffer_load_dwordx4 a[240:243], v21, s[4:7], s16 offen offset:0
    buffer_load_dwordx4 a[244:247], v21, s[4:7], s16 offen offset:1024
    buffer_load_dwordx4 a[248:251], v21, s[4:7], s16 offen offset:2048
    buffer_load_dwordx4 a[252:255], v21, s[4:7], s16 offen offset:3072
    s_barrier
    ds_read_b32 v4, v5
    s_and_b32 s15, s31, 15
    s_cbranch_scc1 L_own
L_ownr:
    s_waitcnt lgkmcnt(0)
    v_readfirstlane_b32 s15, v4
    s_nop 3
    s_cmp_gt_u32 s15, s30
    s_cbranch_scc1 L_redo
    v_mfma_f32_16x16x32_bf16 a[176:179], a[200:203], a[128:131], a[176:179]
    v_mfma_f32_16x16x32_bf16 a[176:179], a[204:207], a[132:135], a[176:179]
    v_mfma_f32_16x16x32_bf16 a[180:183], a[200:203], a[136:139], a[180:183]
    v_mfma_f32_16x16x32_bf16 a[180:183], a[204:207], a[140:143], a[180:183]
    v_mfma_f32_16x16x32_bf16 a[184:187], a[200:203], a[144:147], a[184:187]
    v_mfma_f32_16x16x32_bf16 a[184:187], a[204:207], a[148:151], a[184:187]
    v_mfma_f32_16x16x32_bf16 a[188:191], a[200:203], a[152:155], a[188:191]
    v_mfma_f32_16x16x32_bf16 a[188:191], a[204:207], a[156:159], a[188:191]
    v_mfma_f32_16x16x32_bf16 a[192:195], a[200:203], a[160:163], a[192:195]
    v_mfma_f32_16x16x32_bf16 a[192:195], a[204:207], a[164:167], a[192:195]
    v_mfma_f32_16x16x32_bf16 a[196:199], a[200:203], a[168:171], a[196:199]
    v_mfma_f32_16x16x32_bf16 a[196:199], a[204:207], a[172:175], a[196:199]
    v_bfe_u32 v2, v0, 2, 2
    v_bfe_u32 v3, v0, 5, 1
    v_lshl_add_u32 v2, v3, 2, v2
    v_mul_u32_u24 v2, 272, v2
    v_bfe_u32 v3, v0, 1, 1
    v_lshl_add_u32 v2, v3, 5, v2
    v_bfe_u32 v3, v0, 4, 1
    v_lshl_add_u32 v2, v3, 4, v2
    v_and_b32 v3, 1, v0
    v_lshl_add_u32 v2, v3, 3, v2
    s_lshl_b32 s15, s8, 6
    v_add_u32 v2, s15, v2
    v_accvgpr_read_b32 v64, a176
    v_accvgpr_read_b32 v65, a177
    v_accvgpr_read_b32 v66, a178
    v_accvgpr_read_b32 v67, a179
    v_accvgpr_read_b32 v68, a180
    v_accvgpr_read_b32 v69, a181
    v_accvgpr_read_b32 v70, a182
    v_accvgpr_read_b32 v71, a183
    v_accvgpr_read_b32 v72, a184
    v_accvgpr_read_b32 v73, a185
    v_accvgpr_read_b32 v74, a186
    v_accvgpr_read_b32 v75, a187
    v_accvgpr_read_b32 v76, a188
    v_accvgpr_read_b32 v77, a189
    v_accvgpr_read_b32 v78, a190
    v_accvgpr_read_b32 v79, a191
    v_accvgpr_read_b32 v80, a192
    v_accvgpr_read_b32 v81, a193
    v_accvgpr_read_b32 v82, a194
    v_accvgpr_read_b32 v83, a195
    v_accvgpr_read_b32 v84, a196
    v_accvgpr_read_b32 v85, a197
    v_accvgpr_read_b32 v86, a198
    v_accvgpr_read_b32 v87, a199
    v_cvt_pk_bf16_f32 v64, v64, v65
    v_cvt_pk_bf16_f32 v65, v66, v67
    v_cvt_pk_bf16_f32 v66, v68, v69
    v_cvt_pk_bf16_f32 v67, v70, v71
    v_cvt_pk_bf16_f32 v68, v72, v73
    v_cvt_pk_bf16_f32 v69, v74, v75
    v_cvt_pk_bf16_f32 v70, v76, v77
    v_cvt_pk_bf16_f32 v71, v78, v79
    v_cvt_pk_bf16_f32 v72, v80, v81
    v_cvt_pk_bf16_f32 v73, v82, v83
    v_cvt_pk_bf16_f32 v74, v84, v85
    v_cvt_pk_bf16_f32 v75, v86, v87
    ds_write_b64 v2, v[64:65] offset:16384
    ds_write_b64 v2, v[66:67] offset:18560
    ds_write_b64 v2, v[68:69] offset:20736
    ds_write_b64 v2, v[70:71] offset:22912
    ds_write_b64 v2, v[72:73] offset:25088
    ds_write_b64 v2, v[74:75] offset:27264
    s_waitcnt vmcnt(0) lgkmcnt(0)
    s_barrier
    s_cmp_lg_u32 s8, 0
    s_cbranch_scc1 L_nosig
    s_lshl_b32 s15, s13, 2
    v_mov_b32 v10, s15
    s_add_u32 s16, s30, 1
    v_mov_b32 v11, s16
    s_mov_b64 exec, 1
    buffer_store_dword v11, v10, s[4:7], s54 offen sc1
    s_mov_b64 exec, -1
L_nosig:
    s_cmp_gt_i32 s51, 0
    s_cbranch_scc1 L_left
L_gdone:
    v_and_b32 v8, 15, v0
    v_and_b32 v9, 63, v0
    v_min_u32 v9, 5, v9
    v_lshlrev_b32 v9, 2, v9
    buffer_load_dword v10, v9, s[4:7], s54 offen sc1
    s_mul_i32 s15, s14, 393216
    s_lshl_b32 s16, s13, 12
    s_add_u32 s15, s15, s16
    s_lshl_b32 s16, s8, 10
    s_add_u32 s15, s15, s16
    s_add_u32 s24, s15, 16777216
    s_mul_i32 s15, s14, 12288
    s_lshl_b32 s16, s13, 7
    s_add_u32 s15, s15, s16
    s_add_u32 s25, s15, 41943040
    v_mov_b32 v5, v15
    v_add_u32 v6, 24576, v15
    v_add_u32 v7, 49152, v15
    v_bfe_u32 v2, v0, 2, 2
    v_and_b32 v3, 3, v0
    v_bfe_u32 v4, v0, 5, 1
    v_lshl_add_u32 v2, v4, 2, v2
    v_lshl_add_u32 v2, v3, 4, v2
    v_lshlrev_b32 v14, 2, v2
    v_add_u32 v15, 32, v14
    v_and_b32 v4, 16, v0
    v_cmp_ne_u32 s[64:65], 0, v4
    v_and_b32 v2, 1, v8
    v_lshlrev_b32 v2, 4, v2
    v_mov_b32 v3, 0x3f80
    v_lshlrev_b32 v2, v2, v3
    v_bfe_u32 v3, v8, 1, 1
    v_lshrrev_b32 v4, 2, v8
    v_bfe_u32 v11, v0, 4, 2
    v_xor_b32 v4, v4, v11
    v_lshl_add_u32 v3, v4, 1, v3
    v_cmp_eq_u32 s[66:67], 0, v3
    v_cmp_eq_u32 s[68:69], 1, v3
    v_lshlrev_b32 v8, 3, v8
    v_mov_b32 v36, 0
    v_mov_b32 v37, 0
    v_mov_b32 v38, 0
    v_mov_b32 v39, 0
    v_cndmask_b32 v34, 0, v2, s[66:67]
    v_cndmask_b32 v40, 0, v2, s[66:67]
    v_cndmask_b32 v35, 0, v2, s[68:69]
    v_cndmask_b32 v41, 0, v2, s[68:69]
    v_and_b32 v2, 15, v0
    v_mul_u32_u24 v2, 272, v2
    v_bfe_u32 v3, v0, 4, 2
    v_lshl_add_u32 v2, v3, 4, v2
    ds_read_b128 v[128:131], v2 offset:16384
    ds_read_b128 v[132:135], v2 offset:16448
    ds_read_b128 v[136:139], v2 offset:16512
    ds_read_b128 v[140:143], v2 offset:16576
    ds_read_b128 v[144:147], v2 offset:20736
    ds_read_b128 v[148:151], v2 offset:20800
    ds_read_b128 v[152:155], v2 offset:20864
    ds_read_b128 v[156:159], v2 offset:20928
    ds_read_b128 v[160:163], v2 offset:25088
    ds_read_b128 v[164:167], v2 offset:25152
    ds_read_b128 v[168:171], v2 offset:25216
    ds_read_b128 v[172:175], v2 offset:25280
    v_accvgpr_read_b32 v3, a208
    v_accvgpr_read_b32 v4, a209
    v_lshlrev_b32 v96, 16, v3
    v_and_b32 v97, 0xffff0000, v3
    v_lshlrev_b32 v98, 16, v4
    v_and_b32 v99, 0xffff0000, v4
    v_accvgpr_read_b32 v3, a210
    v_accvgpr_read_b32 v4, a211
    v_lshlrev_b32 v100, 16, v3
    v_and_b32 v101, 0xffff0000, v3
    v_lshlrev_b32 v102, 16, v4
    v_and_b32 v103, 0xffff0000, v4
    v_accvgpr_read_b32 v80, a220
    v_accvgpr_read_b32 v3, a212
    v_accvgpr_read_b32 v4, a213
    v_lshlrev_b32 v104, 16, v3
    v_and_b32 v105, 0xffff0000, v3
    v_lshlrev_b32 v106, 16, v4
    v_and_b32 v107, 0xffff0000, v4
    v_accvgpr_read_b32 v3, a214
    v_accvgpr_read_b32 v4, a215
    v_lshlrev_b32 v108, 16, v3
    v_and_b32 v109, 0xffff0000, v3
    v_lshlrev_b32 v110, 16, v4
    v_and_b32 v111, 0xffff0000, v4
    v_accvgpr_read_b32 v81, a221
    v_accvgpr_read_b32 v3, a216
    v_accvgpr_read_b32 v4, a217
    v_lshlrev_b32 v112, 16, v3
    v_and_b32 v113, 0xffff0000, v3
    v_lshlrev_b32 v114, 16, v4
    v_and_b32 v115, 0xffff0000, v4
    v_accvgpr_read_b32 v3, a218
    v_accvgpr_read_b32 v4, a219
    v_lshlrev_b32 v116, 16, v3
    v_and_b32 v117, 0xffff0000, v3
    v_lshlrev_b32 v118, 16, v4
    v_and_b32 v119, 0xffff0000, v4
    v_accvgpr_read_b32 v82, a222
    s_waitcnt lgkmcnt(8)
    v_mfma_f32_16x16x32_bf16 v[176:179], a[224:227], v[128:131], 0
    v_mfma_f32_16x16x32_bf16 v[180:183], a[240:243], v[128:131], 0
    v_mfma_f32_16x16x32_bf16 v[176:179], a[228:231], v[132:135], v[176:179]
    v_mfma_f32_16x16x32_bf16 v[180:183], a[244:247], v[132:135], v[180:183]
    v_mfma_f32_16x16x32_bf16 v[176:179], a[232:235], v[136:139], v[176:179]
    v_mfma_f32_16x16x32_bf16 v[180:183], a[248:251], v[136:139], v[180:183]
    v_mfma_f32_16x16x32_bf16 v[176:179], a[236:239], v[140:143], v[176:179]
    v_mfma_f32_16x16x32_bf16 v[180:183], a[252:255], v[140:143], v[180:183]
    v_lshlrev_b32 v80, 16, v80
    s_waitcnt lgkmcnt(4)
    v_mfma_f32_16x16x32_bf16 v[184:187], a[224:227], v[144:147], 0
    v_mfma_f32_16x16x32_bf16 v[188:191], a[240:243], v[144:147], 0
    v_mfma_f32_16x16x32_bf16 v[184:187], a[228:231], v[148:151], v[184:187]
    v_mfma_f32_16x16x32_bf16 v[188:191], a[244:247], v[148:151], v[188:191]
    v_mfma_f32_16x16x32_bf16 v[184:187], a[232:235], v[152:155], v[184:187]
    v_mfma_f32_16x16x32_bf16 v[188:191], a[248:251], v[152:155], v[188:191]
    v_mfma_f32_16x16x32_bf16 v[184:187], a[236:239], v[156:159], v[184:187]
    v_mfma_f32_16x16x32_bf16 v[188:191], a[252:255], v[156:159], v[188:191]
    v_lshlrev_b32 v81, 16, v81
    s_waitcnt lgkmcnt(0)
    v_mfma_f32_16x16x32_bf16 v[192:195], a[224:227], v[160:163], 0
    v_mfma_f32_16x16x32_bf16 v[196:199], a[240:243], v[160:163], 0
    v_mfma_f32_16x16x32_bf16 v[192:195], a[228:231], v[164:167], v[192:195]
    v_mfma_f32_16x16x32_bf16 v[196:199], a[244:247], v[164:167], v[196:199]
    v_mfma_f32_16x16x32_bf16 v[192:195], a[232:235], v[168:171], v[192:195]
    v_mfma_f32_16x16x32_bf16 v[196:199], a[248:251], v[168:171], v[196:199]
    v_mfma_f32_16x16x32_bf16 v[192:195], a[236:239], v[172:175], v[192:195]
    v_mfma_f32_16x16x32_bf16 v[196:199], a[252:255], v[172:175], v[196:199]
    v_lshlrev_b32 v82, 16, v82
    s_mov_b32 s16, s13
    s_lshl_b32 s15, s16, 11
    s_add_u32 s72, s25, s15
    s_add_u32 s16, s16, 1
    s_cmp_eq_u32 s16, 6
    s_cselect_b32 s16, 0, s16
    s_lshl_b32 s15, s16, 11
    s_add_u32 s73, s25, s15
    s_lshl_b32 s15, s16, 16
    s_add_u32 s79, s24, s15
    s_add_u32 s16, s16, 1
    s_cmp_eq_u32 s16, 6
    s_cselect_b32 s16, 0, s16
    s_lshl_b32 s15, s16, 11
    s_add_u32 s74, s25, s15
    s_lshl_b32 s15, s16, 16
    s_add_u32 s80, s24, s15
    s_add_u32 s16, s16, 1
    s_cmp_eq_u32 s16, 6
    s_cselect_b32 s16, 0, s16
    s_lshl_b32 s15, s16, 11
    s_add_u32 s75, s25, s15
    s_lshl_b32 s15, s16, 16
    s_add_u32 s81, s24, s15
    s_add_u32 s16, s16, 1
    s_cmp_eq_u32 s16, 6
    s_cselect_b32 s16, 0, s16
    s_lshl_b32 s15, s16, 11
    s_add_u32 s76, s25, s15
    s_lshl_b32 s15, s16, 16
    s_add_u32 s82, s24, s15
    s_add_u32 s16, s16, 1
    s_cmp_eq_u32 s16, 6
    s_cselect_b32 s16, 0, s16
    s_lshl_b32 s15, s16, 11
    s_add_u32 s77, s25, s15
    s_lshl_b32 s15, s16, 16
    s_add_u32 s83, s24, s15
    s_add_u32 s16, s16, 1
    s_cmp_eq_u32 s16, 6
    s_cselect_b32 s16, 0, s16
    v_mul_f32 v26, v176, v80
    v_mul_f32 v27, v177, v80
    v_mul_f32 v28, v178, v80
    v_mul_f32 v29, v179, v80
    v_mul_f32 v30, v180, v80
    v_mul_f32 v31, v181, v80
    v_mul_f32 v32, v182, v80
    v_mul_f32 v33, v183, v80
    v_mul_f32 v236, v184, v81
    v_mul_f32 v237, v185, v81
    v_mul_f32 v238, v186, v81
    v_mul_f32 v239, v187, v81
    v_mul_f32 v240, v188, v81
    v_mul_f32 v241, v189, v81
    v_mul_f32 v242, v190, v81
    v_mul_f32 v243, v191, v81
    v_mul_f32 v244, v192, v82
    v_mul_f32 v245, v193, v82
    v_mul_f32 v246, v194, v82
    v_mul_f32 v247, v195, v82
    v_mul_f32 v248, v196, v82
    v_mul_f32 v249, v197, v82
    v_mul_f32 v250, v198, v82
    v_mul_f32 v251, v199, v82
    s_lshl_b32 s15, s8, 10
    v_add_u32 v2, s15, v21
    ds_read_b128 v[128:131], v2 offset:0
    ds_read_b128 v[152:155], v2 offset:4096
    ds_read_b128 v[176:179], v2 offset:8192
    s_waitcnt lgkmcnt(0)
    s_mov_b32 s52, 0
L_poll:
    buffer_load_dword v11, v9, s[4:7], s54 offen sc1
    s_waitcnt vmcnt(1)
    v_cmp_eq_u32 vcc, 0, v10
    s_cbranch_vccz L_poll_done
    s_add_u32 s52, s52, 1
    s_cmp_gt_u32 s52, 0x1000000
    s_cbranch_scc1 L_k2_end
    buffer_load_dword v10, v9, s[4:7], s54 offen sc1
    s_waitcnt vmcnt(1)
    v_cmp_eq_u32 vcc, 0, v11
    s_cbranch_vccnz L_poll
    v_mov_b32 v12, v11
    s_branch L_poll_d2
L_poll_done:
    v_mov_b32 v12, v10
L_poll_d2:
    v_cmp_ne_u32 vcc, 1, v12
    buffer_load_dwordx2 v[200:201], v8, s[4:7], s72 offen offset:0 sc1
    buffer_load_dwordx2 v[202:203], v8, s[4:7], s73 offen offset:0 sc1
    buffer_load_dwordx2 v[204:205], v8, s[4:7], s74 offen offset:0 sc1
    buffer_load_dwordx2 v[206:207], v8, s[4:7], s75 offen offset:0 sc1
    buffer_load_dwordx2 v[208:209], v8, s[4:7], s76 offen offset:0 sc1
    buffer_load_dwordx2 v[210:211], v8, s[4:7], s77 offen offset:0 sc1
    s_add_u32 s15, s79, 0
    buffer_load_dwordx4 v[132:135], v21, s[4:7], s15 offen sc1
    s_add_u32 s15, s80, 0
    buffer_load_dwordx4 v[136:139], v21, s[4:7], s15 offen sc1
    s_add_u32 s15, s81, 0
    buffer_load_dwordx4 v[140:143], v21, s[4:7], s15 offen sc1
    s_add_u32 s15, s82, 0
    buffer_load_dwordx4 v[144:147], v21, s[4:7], s15 offen sc1
    s_add_u32 s15, s83, 0
    buffer_load_dwordx4 v[148:151], v21, s[4:7], s15 offen sc1
    buffer_load_dwordx2 v[212:213], v8, s[4:7], s72 offen offset:768 sc1
    buffer_load_dwordx2 v[214:215], v8, s[4:7], s73 offen offset:768 sc1
    buffer_load_dwordx2 v[216:217], v8, s[4:7], s74 offen offset:768 sc1
    buffer_load_dwordx2 v[218:219], v8, s[4:7], s75 offen offset:768 sc1
    buffer_load_dwordx2 v[220:221], v8, s[4:7], s76 offen offset:768 sc1
    buffer_load_dwordx2 v[222:223], v8, s[4:7], s77 offen offset:768 sc1
    s_add_u32 s15, s79, 24576
    buffer_load_dwordx4 v[156:159], v21, s[4:7], s15 offen sc1
    s_add_u32 s15, s80, 24576
    buffer_load_dwordx4 v[160:163], v21, s[4:7], s15 offen sc1
    s_add_u32 s15, s81, 24576
    buffer_load_dwordx4 v[164:167], v21, s[4:7], s15 offen sc1
    s_add_u32 s15, s82, 24576
    buffer_load_dwordx4 v[168:171], v21, s[4:7], s15 offen sc1
    s_add_u32 s15, s83, 24576
    buffer_load_dwordx4 v[172:175], v21, s[4:7], s15 offen sc1
    s_cmp_gt_u32 s13, 3
    s_cbranch_scc1 L_no3
    buffer_load_dwordx2 v[224:225], v8, s[4:7], s72 offen offset:1536 sc1
    buffer_load_dwordx2 v[226:227], v8, s[4:7], s73 offen offset:1536 sc1
    buffer_load_dwordx2 v[228:229], v8, s[4:7], s74 offen offset:1536 sc1
    buffer_load_dwordx2 v[230:231], v8, s[4:7], s75 offen offset:1536 sc1
    buffer_load_dwordx2 v[232:233], v8, s[4:7], s76 offen offset:1536 sc1
    buffer_load_dwordx2 v[234:235], v8, s[4:7], s77 offen offset:1536 sc1
    s_add_u32 s15, s79, 49152
    buffer_load_dwordx4 v[180:183], v21, s[4:7], s15 offen sc1
    s_add_u32 s15, s80, 49152
    buffer_load_dwordx4 v[184:187], v21, s[4:7], s15 offen sc1
    s_add_u32 s15, s81, 49152
    buffer_load_dwordx4 v[188:191], v21, s[4:7], s15 offen sc1
    s_add_u32 s15, s82, 49152
    buffer_load_dwordx4 v[192:195], v21, s[4:7], s15 offen sc1
    s_add_u32 s15, s83, 49152
    buffer_load_dwordx4 v[196:199], v21, s[4:7], s15 offen sc1
L_ld_done:
    s_cbranch_vccnz L_general
    v_mfma_f32_16x16x32_bf16 v[80:83], v[34:37], v[128:131], 0
    v_mfma_f32_16x16x32_bf16 v[84:87], v[38:41], v[128:131], 0
    s_waitcnt vmcnt(26)
    v_mfma_f32_16x16x32_bf16 v[80:83], v[34:37], v[132:135], v[80:83]
    v_mfma_f32_16x16x32_bf16 v[84:87], v[38:41], v[132:135], v[84:87]
    v_add_f32 v42, v201, v203
    s_waitcnt vmcnt(25)
    v_mfma_f32_16x16x32_bf16 v[80:83], v[34:37], v[136:139], v[80:83]
    v_mfma_f32_16x16x32_bf16 v[84:87], v[38:41], v[136:139], v[84:87]
    v_add_f32 v42, v42, v205
    s_waitcnt vmcnt(24)
    v_mfma_f32_16x16x32_bf16 v[80:83], v[34:37], v[140:143], v[80:83]
    v_mfma_f32_16x16x32_bf16 v[84:87], v[38:41], v[140:143], v[84:87]
    v_add_f32 v42, v42, v207
    s_waitcnt vmcnt(23)
    v_mfma_f32_16x16x32_bf16 v[80:83], v[34:37], v[144:147], v[80:83]
    v_mfma_f32_16x16x32_bf16 v[84:87], v[38:41], v[144:147], v[84:87]
    v_add_f32 v42, v42, v209
    s_waitcnt vmcnt(22)
    v_mfma_f32_16x16x32_bf16 v[80:83], v[34:37], v[148:151], v[80:83]
    v_mfma_f32_16x16x32_bf16 v[84:87], v[38:41], v[148:151], v[84:87]
    v_add_f32 v42, v42, v211
    v_rcp_f32 v42, v42
    v_mfma_f32_16x16x32_bf16 v[88:91], v[34:37], v[152:155], 0
    v_mfma_f32_16x16x32_bf16 v[92:95], v[38:41], v[152:155], 0
    s_waitcnt vmcnt(15)
    v_mfma_f32_16x16x32_bf16 v[88:91], v[34:37], v[156:159], v[88:91]
    v_mfma_f32_16x16x32_bf16 v[92:95], v[38:41], v[156:159], v[92:95]
    v_add_f32 v43, v213, v215
    s_waitcnt vmcnt(14)
    v_mfma_f32_16x16x32_bf16 v[88:91], v[34:37], v[160:163], v[88:91]
    v_mfma_f32_16x16x32_bf16 v[92:95], v[38:41], v[160:163], v[92:95]
    v_add_f32 v43, v43, v217
    s_waitcnt vmcnt(13)
    v_mfma_f32_16x16x32_bf16 v[88:91], v[34:37], v[164:167], v[88:91]
    v_mfma_f32_16x16x32_bf16 v[92:95], v[38:41], v[164:167], v[92:95]
    v_add_f32 v43, v43, v219
    s_waitcnt vmcnt(12)
    v_mfma_f32_16x16x32_bf16 v[88:91], v[34:37], v[168:171], v[88:91]
    v_mfma_f32_16x16x32_bf16 v[92:95], v[38:41], v[168:171], v[92:95]
    v_add_f32 v43, v43, v221
    s_waitcnt vmcnt(11)
    v_mfma_f32_16x16x32_bf16 v[88:91], v[34:37], v[172:175], v[88:91]
    v_mfma_f32_16x16x32_bf16 v[92:95], v[38:41], v[172:175], v[92:95]
    v_add_f32 v43, v43, v223
    v_rcp_f32 v43, v43
    v_fmac_f32 v26, v80, v42
    v_fmac_f32 v27, v81, v42
    v_fmac_f32 v28, v82, v42
    v_fmac_f32 v29, v83, v42
    v_fmac_f32 v30, v84, v42
    v_fmac_f32 v31, v85, v42
    v_fmac_f32 v32, v86, v42
    v_fmac_f32 v33, v87, v42
    ds_bpermute_b32 v64, v14, v26
    ds_bpermute_b32 v65, v14, v27
    ds_bpermute_b32 v66, v14, v28
    ds_bpermute_b32 v67, v14, v29
    ds_bpermute_b32 v68, v14, v30
    ds_bpermute_b32 v69, v14, v31
    ds_bpermute_b32 v70, v14, v32
    ds_bpermute_b32 v71, v14, v33
    ds_bpermute_b32 v72, v15, v26
    ds_bpermute_b32 v73, v15, v27
    ds_bpermute_b32 v74, v15, v28
    ds_bpermute_b32 v75, v15, v29
    ds_bpermute_b32 v76, v15, v30
    ds_bpermute_b32 v77, v15, v31
    ds_bpermute_b32 v78, v15, v32
    ds_bpermute_b32 v79, v15, v33
    v_mfma_f32_16x16x32_bf16 v[120:123], v[34:37], v[176:179], 0
    v_mfma_f32_16x16x32_bf16 v[124:127], v[38:41], v[176:179], 0
    s_waitcnt vmcnt(4)
    v_mfma_f32_16x16x32_bf16 v[120:123], v[34:37], v[180:183], v[120:123]
    v_mfma_f32_16x16x32_bf16 v[124:127], v[38:41], v[180:183], v[124:127]
    v_add_f32 v44, v225, v227
    s_waitcnt vmcnt(3)
    v_mfma_f32_16x16x32_bf16 v[120:123], v[34:37], v[184:187], v[120:123]
    v_mfma_f32_16x16x32_bf16 v[124:127], v[38:41], v[184:187], v[124:127]
    v_add_f32 v44, v44, v229
    s_waitcnt vmcnt(2)
    v_mfma_f32_16x16x32_bf16 v[120:123], v[34:37], v[188:191], v[120:123]
    v_mfma_f32_16x16x32_bf16 v[124:127], v[38:41], v[188:191], v[124:127]
    v_add_f32 v44, v44, v231
    s_waitcnt vmcnt(1)
    v_mfma_f32_16x16x32_bf16 v[120:123], v[34:37], v[192:195], v[120:123]
    v_mfma_f32_16x16x32_bf16 v[124:127], v[38:41], v[192:195], v[124:127]
    v_add_f32 v44, v44, v233
    s_waitcnt vmcnt(0)
    v_mfma_f32_16x16x32_bf16 v[120:123], v[34:37], v[196:199], v[120:123]
    v_mfma_f32_16x16x32_bf16 v[124:127], v[38:41], v[196:199], v[124:127]
    v_add_f32 v44, v44, v235
    v_rcp_f32 v44, v44
    v_fmac_f32 v236, v88, v43
    v_fmac_f32 v237, v89, v43
    v_fmac_f32 v238, v90, v43
    v_fmac_f32 v239, v91, v43
    v_fmac_f32 v240, v92, v43
    v_fmac_f32 v241, v93, v43
    v_fmac_f32 v242, v94, v43
    v_fmac_f32 v243, v95, v43
    ds_bpermute_b32 v128, v14, v236
    ds_bpermute_b32 v129, v14, v237
    ds_bpermute_b32 v130, v14, v238
    ds_bpermute_b32 v131, v14, v239
    ds_bpermute_b32 v132, v14, v240
    ds_bpermute_b32 v133, v14, v241
    ds_bpermute_b32 v134, v14, v242
    ds_bpermute_b32 v135, v14, v243
    ds_bpermute_b32 v136, v15, v236
    ds_bpermute_b32 v137, v15, v237
    ds_bpermute_b32 v138, v15, v238
    ds_bpermute_b32 v139, v15, v239
    ds_bpermute_b32 v140, v15, v240
    ds_bpermute_b32 v141, v15, v241
    ds_bpermute_b32 v142, v15, v242
    ds_bpermute_b32 v143, v15, v243
    s_waitcnt lgkmcnt(15)
    v_cndmask_b32 v64, v64, v68, s[64:65]
    v_add_f32 v96, v96, v64
    v_cndmask_b32 v65, v65, v69, s[64:65]
    v_add_f32 v97, v97, v65
    v_cndmask_b32 v66, v66, v70, s[64:65]
    v_add_f32 v98, v98, v66
    v_cndmask_b32 v67, v67, v71, s[64:65]
    v_add_f32 v99, v99, v67
    v_cvt_pk_bf16_f32 v56, v96, v97
    v_cvt_pk_bf16_f32 v57, v98, v99
    buffer_store_dwordx2 v[56:57], v5, s[40:43], 0 offen offset:0 nt
    s_waitcnt lgkmcnt(15)
    v_cndmask_b32 v72, v72, v76, s[64:65]
    v_add_f32 v100, v100, v72
    v_cndmask_b32 v73, v73, v77, s[64:65]
    v_add_f32 v101, v101, v73
    v_cndmask_b32 v74, v74, v78, s[64:65]
    v_add_f32 v102, v102, v74
    v_cndmask_b32 v75, v75, v79, s[64:65]
    v_add_f32 v103, v103, v75
    v_cvt_pk_bf16_f32 v58, v100, v101
    v_cvt_pk_bf16_f32 v59, v102, v103
    buffer_store_dwordx2 v[58:59], v5, s[40:43], 0 offen offset:2048 nt
    v_fmac_f32 v244, v120, v44
    v_fmac_f32 v245, v121, v44
    v_fmac_f32 v246, v122, v44
    v_fmac_f32 v247, v123, v44
    v_fmac_f32 v248, v124, v44
    v_fmac_f32 v249, v125, v44
    v_fmac_f32 v250, v126, v44
    v_fmac_f32 v251, v127, v44
    ds_bpermute_b32 v152, v14, v244
    ds_bpermute_b32 v153, v14, v245
    ds_bpermute_b32 v154, v14, v246
    ds_bpermute_b32 v155, v14, v247
    ds_bpermute_b32 v156, v14, v248
    ds_bpermute_b32 v157, v14, v249
    ds_bpermute_b32 v158, v14, v250
    ds_bpermute_b32 v159, v14, v251
    ds_bpermute_b32 v160, v15, v244
    ds_bpermute_b32 v161, v15, v245
    ds_bpermute_b32 v162, v15, v246
    ds_bpermute_b32 v163, v15, v247
    ds_bpermute_b32 v164, v15, v248
    ds_bpermute_b32 v165, v15, v249
    ds_bpermute_b32 v166, v15, v250
    ds_bpermute_b32 v167, v15, v251
    s_waitcnt lgkmcnt(15)
    v_cndmask_b32 v128, v128, v132, s[64:65]
    v_add_f32 v104, v104, v128
    v_cndmask_b32 v129, v129, v133, s[64:65]
    v_add_f32 v105, v105, v129
    v_cndmask_b32 v130, v130, v134, s[64:65]
    v_add_f32 v106, v106, v130
    v_cndmask_b32 v131, v131, v135, s[64:65]
    v_add_f32 v107, v107, v131
    v_cvt_pk_bf16_f32 v60, v104, v105
    v_cvt_pk_bf16_f32 v61, v106, v107
    buffer_store_dwordx2 v[60:61], v6, s[40:43], 0 offen offset:0 nt
    s_waitcnt lgkmcnt(15)
    v_cndmask_b32 v136, v136, v140, s[64:65]
    v_add_f32 v108, v108, v136
    v_cndmask_b32 v137, v137, v141, s[64:65]
    v_add_f32 v109, v109, v137
    v_cndmask_b32 v138, v138, v142, s[64:65]
    v_add_f32 v110, v110, v138
    v_cndmask_b32 v139, v139, v143, s[64:65]
    v_add_f32 v111, v111, v139
    v_cvt_pk_bf16_f32 v62, v108, v109
    v_cvt_pk_bf16_f32 v63, v110, v111
    buffer_store_dwordx2 v[62:63], v6, s[40:43], 0 offen offset:2048 nt
    s_waitcnt lgkmcnt(8)
    v_cndmask_b32 v152, v152, v156, s[64:65]
    v_add_f32 v112, v112, v152
    v_cndmask_b32 v153, v153, v157, s[64:65]
    v_add_f32 v113, v113, v153
    v_cndmask_b32 v154, v154, v158, s[64:65]
    v_add_f32 v114, v114, v154
    v_cndmask_b32 v155, v155, v159, s[64:65]
    v_add_f32 v115, v115, v155
    v_cvt_pk_bf16_f32 v46, v112, v113
    v_cvt_pk_bf16_f32 v47, v114, v115
    buffer_store_dwordx2 v[46:47], v7, s[40:43], 0 offen offset:0 nt
    s_waitcnt lgkmcnt(0)
    v_cndmask_b32 v160, v160, v164, s[64:65]
    v_add_f32 v116, v116, v160
    v_cndmask_b32 v161, v161, v165, s[64:65]
    v_add_f32 v117, v117, v161
    v_cndmask_b32 v162, v162, v166, s[64:65]
    v_add_f32 v118, v118, v162
    v_cndmask_b32 v163, v163, v167, s[64:65]
    v_add_f32 v119, v119, v163
    v_cvt_pk_bf16_f32 v48, v116, v117
    v_cvt_pk_bf16_f32 v49, v118, v119
    buffer_store_dwordx2 v[48:49], v7, s[40:43], 0 offen offset:2048 nt
    s_branch L_k2_done
L_no3:
    s_cbranch_vccnz L_no3g
    v_mfma_f32_16x16x32_bf16 v[80:83], v[34:37], v[128:131], 0
    v_mfma_f32_16x16x32_bf16 v[84:87], v[38:41], v[128:131], 0
    s_waitcnt vmcnt(15)
    v_mfma_f32_16x16x32_bf16 v[80:83], v[34:37], v[132:135], v[80:83]
    v_mfma_f32_16x16x32_bf16 v[84:87], v[38:41], v[132:135], v[84:87]
    v_add_f32 v42, v201, v203
    s_waitcnt vmcnt(14)
    v_mfma_f32_16x16x32_bf16 v[80:83], v[34:37], v[136:139], v[80:83]
    v_mfma_f32_16x16x32_bf16 v[84:87], v[38:41], v[136:139], v[84:87]
    v_add_f32 v42, v42, v205
    s_waitcnt vmcnt(13)
    v_mfma_f32_16x16x32_bf16 v[80:83], v[34:37], v[140:143], v[80:83]
    v_mfma_f32_16x16x32_bf16 v[84:87], v[38:41], v[140:143], v[84:87]
    v_add_f32 v42, v42, v207
    s_waitcnt vmcnt(12)
    v_mfma_f32_16x16x32_bf16 v[80:83], v[34:37], v[144:147], v[80:83]
    v_mfma_f32_16x16x32_bf16 v[84:87], v[38:41], v[144:147], v[84:87]
    v_add_f32 v42, v42, v209
    s_waitcnt vmcnt(11)
    v_mfma_f32_16x16x32_bf16 v[80:83], v[34:37], v[148:151], v[80:83]
    v_mfma_f32_16x16x32_bf16 v[84:87], v[38:41], v[148:151], v[84:87]
    v_add_f32 v42, v42, v211
    v_rcp_f32 v42, v42
    v_mfma_f32_16x16x32_bf16 v[88:91], v[34:37], v[152:155], 0
    v_mfma_f32_16x16x32_bf16 v[92:95], v[38:41], v[152:155], 0
    s_waitcnt vmcnt(4)
    v_mfma_f32_16x16x32_bf16 v[88:91], v[34:37], v[156:159], v[88:91]
    v_mfma_f32_16x16x32_bf16 v[92:95], v[38:41], v[156:159], v[92:95]
    v_add_f32 v43, v213, v215
    s_waitcnt vmcnt(3)
    v_mfma_f32_16x16x32_bf16 v[88:91], v[34:37], v[160:163], v[88:91]
    v_mfma_f32_16x16x32_bf16 v[92:95], v[38:41], v[160:163], v[92:95]
    v_add_f32 v43, v43, v217
    s_waitcnt vmcnt(2)
    v_mfma_f32_16x16x32_bf16 v[88:91], v[34:37], v[164:167], v[88:91]
    v_mfma_f32_16x16x32_bf16 v[92:95], v[38:41], v[164:167], v[92:95]
    v_add_f32 v43, v43, v219
    s_waitcnt vmcnt(1)
    v_mfma_f32_16x16x32_bf16 v[88:91], v[34:37], v[168:171], v[88:91]
    v_mfma_f32_16x16x32_bf16 v[92:95], v[38:41], v[168:171], v[92:95]
    v_add_f32 v43, v43, v221
    s_waitcnt vmcnt(0)
    v_mfma_f32_16x16x32_bf16 v[88:91], v[34:37], v[172:175], v[88:91]
    v_mfma_f32_16x16x32_bf16 v[92:95], v[38:41], v[172:175], v[92:95]
    v_add_f32 v43, v43, v223
    v_rcp_f32 v43, v43
    v_fmac_f32 v26, v80, v42
    v_fmac_f32 v27, v81, v42
    v_fmac_f32 v28, v82, v42
    v_fmac_f32 v29, v83, v42
    v_fmac_f32 v30, v84, v42
    v_fmac_f32 v31, v85, v42
    v_fmac_f32 v32, v86, v42
    v_fmac_f32 v33, v87, v42
    ds_bpermute_b32 v64, v14, v26
    ds_bpermute_b32 v65, v14, v27
    ds_bpermute_b32 v66, v14, v28
    ds_bpermute_b32 v67, v14, v29
    ds_bpermute_b32 v68, v14, v30
    ds_bpermute_b32 v69, v14, v31
    ds_bpermute_b32 v70, v14, v32
    ds_bpermute_b32 v71, v14, v33
    ds_bpermute_b32 v72, v15, v26
    ds_bpermute_b32 v73, v15, v27
    ds_bpermute_b32 v74, v15, v28
    ds_bpermute_b32 v75, v15, v29
    ds_bpermute_b32 v76, v15, v30
    ds_bpermute_b32 v77, v15, v31
    ds_bpermute_b32 v78, v15, v32
    ds_bpermute_b32 v79, v15, v33
    v_fmac_f32 v236, v88, v43
    v_fmac_f32 v237, v89, v43
    v_fmac_f32 v238, v90, v43
    v_fmac_f32 v239, v91, v43
    v_fmac_f32 v240, v92, v43
    v_fmac_f32 v241, v93, v43
    v_fmac_f32 v242, v94, v43
    v_fmac_f32 v243, v95, v43
    ds_bpermute_b32 v128, v14, v236
    ds_bpermute_b32 v129, v14, v237
    ds_bpermute_b32 v130, v14, v238
    ds_bpermute_b32 v131, v14, v239
    ds_bpermute_b32 v132, v14, v240
    ds_bpermute_b32 v133, v14, v241
    ds_bpermute_b32 v134, v14, v242
    ds_bpermute_b32 v135, v14, v243
    ds_bpermute_b32 v136, v15, v236
    ds_bpermute_b32 v137, v15, v237
    ds_bpermute_b32 v138, v15, v238
    ds_bpermute_b32 v139, v15, v239
    ds_bpermute_b32 v140, v15, v240
    ds_bpermute_b32 v141, v15, v241
    ds_bpermute_b32 v142, v15, v242
    ds_bpermute_b32 v143, v15, v243
    s_waitcnt lgkmcnt(15)
    v_cndmask_b32 v64, v64, v68, s[64:65]
    v_add_f32 v96, v96, v64
    v_cndmask_b32 v65, v65, v69, s[64:65]
    v_add_f32 v97, v97, v65
    v_cndmask_b32 v66, v66, v70, s[64:65]
    v_add_f32 v98, v98, v66
    v_cndmask_b32 v67, v67, v71, s[64:65]
    v_add_f32 v99, v99, v67
    v_cvt_pk_bf16_f32 v56, v96, v97
    v_cvt_pk_bf16_f32 v57, v98, v99
    buffer_store_dwordx2 v[56:57], v5, s[40:43], 0 offen offset:0 nt
    s_waitcnt lgkmcnt(15)
    v_cndmask_b32 v72, v72, v76, s[64:65]
    v_add_f32 v100, v100, v72
    v_cndmask_b32 v73, v73, v77, s[64:65]
    v_add_f32 v101, v101, v73
    v_cndmask_b32 v74, v74, v78, s[64:65]
    v_add_f32 v102, v102, v74
    v_cndmask_b32 v75, v75, v79, s[64:65]
    v_add_f32 v103, v103, v75
    v_cvt_pk_bf16_f32 v58, v100, v101
    v_cvt_pk_bf16_f32 v59, v102, v103
    buffer_store_dwordx2 v[58:59], v5, s[40:43], 0 offen offset:2048 nt
    s_waitcnt lgkmcnt(8)
    v_cndmask_b32 v128, v128, v132, s[64:65]
    v_add_f32 v104, v104, v128
    v_cndmask_b32 v129, v129, v133, s[64:65]
    v_add_f32 v105, v105, v129
    v_cndmask_b32 v130, v130, v134, s[64:65]
    v_add_f32 v106, v106, v130
    v_cndmask_b32 v131, v131, v135, s[64:65]
    v_add_f32 v107, v107, v131
    v_cvt_pk_bf16_f32 v60, v104, v105
    v_cvt_pk_bf16_f32 v61, v106, v107
    buffer_store_dwordx2 v[60:61], v6, s[40:43], 0 offen offset:0 nt
    s_waitcnt lgkmcnt(0)
    v_cndmask_b32 v136, v136, v140, s[64:65]
    v_add_f32 v108, v108, v136
    v_cndmask_b32 v137, v137, v141, s[64:65]
    v_add_f32 v109, v109, v137
    v_cndmask_b32 v138, v138, v142, s[64:65]
    v_add_f32 v110, v110, v138
    v_cndmask_b32 v139, v139, v143, s[64:65]
    v_add_f32 v111, v111, v139
    v_cvt_pk_bf16_f32 v62, v108, v109
    v_cvt_pk_bf16_f32 v63, v110, v111
    buffer_store_dwordx2 v[62:63], v6, s[40:43], 0 offen offset:2048 nt
    s_branch L_k2_done
L_no3g:
    s_waitcnt vmcnt(0)
L_general:
    s_waitcnt vmcnt(22)
    v_max3_f32 v44, v200, v202, v204
    v_max3_f32 v44, v44, v206, v208
    v_max_f32 v44, v44, v210
    v_sub_f32 v200, v200, v44
    v_sub_f32 v202, v202, v44
    v_sub_f32 v204, v204, v44
    v_sub_f32 v206, v206, v44
    v_sub_f32 v208, v208, v44
    v_sub_f32 v210, v210, v44
    v_exp_f32 v200, v200
    v_exp_f32 v202, v202
    v_exp_f32 v204, v204
    v_exp_f32 v206, v206
    v_exp_f32 v208, v208
    v_exp_f32 v210, v210
    s_nop 0
    v_mul_f32 v45, v200, v201
    v_fmac_f32 v45, v202, v203
    v_fmac_f32 v45, v204, v205
    v_fmac_f32 v45, v206, v207
    v_fmac_f32 v45, v208, v209
    v_fmac_f32 v45, v210, v211
    v_rcp_f32 v45, v45
    s_nop 0
    v_mul_f32 v200, v200, v45
    v_mul_f32 v202, v202, v45
    v_mul_f32 v204, v204, v45
    v_mul_f32 v206, v206, v45
    v_mul_f32 v208, v208, v45
    v_mul_f32 v210, v210, v45
    v_lshlrev_b32 v42, 16, v128
    v_and_b32 v43, 0xffff0000, v128
    v_fmac_f32 v26, v42, v200
    v_fmac_f32 v27, v43, v200
    v_lshlrev_b32 v42, 16, v129
    v_and_b32 v43, 0xffff0000, v129
    v_fmac_f32 v28, v42, v200
    v_fmac_f32 v29, v43, v200
    v_lshlrev_b32 v42, 16, v130
    v_and_b32 v43, 0xffff0000, v130
    v_fmac_f32 v30, v42, v200
    v_fmac_f32 v31, v43, v200
    v_lshlrev_b32 v42, 16, v131
    v_and_b32 v43, 0xffff0000, v131
    v_fmac_f32 v32, v42, v200
    v_fmac_f32 v33, v43, v200
    v_lshlrev_b32 v42, 16, v132
    v_and_b32 v43, 0xffff0000, v132
    v_fmac_f32 v26, v42, v202
    v_fmac_f32 v27, v43, v202
    v_lshlrev_b32 v42, 16, v133
    v_and_b32 v43, 0xffff0000, v133
    v_fmac_f32 v28, v42, v202
    v_fmac_f32 v29, v43, v202
    v_lshlrev_b32 v42, 16, v134
    v_and_b32 v43, 0xffff0000, v134
    v_fmac_f32 v30, v42, v202
    v_fmac_f32 v31, v43, v202
    v_lshlrev_b32 v42, 16, v135
    v_and_b32 v43, 0xffff0000, v135
    v_fmac_f32 v32, v42, v202
    v_fmac_f32 v33, v43, v202
    v_lshlrev_b32 v42, 16, v136
    v_and_b32 v43, 0xffff0000, v136
    v_fmac_f32 v26, v42, v204
    v_fmac_f32 v27, v43, v204
    v_lshlrev_b32 v42, 16, v137
    v_and_b32 v43, 0xffff0000, v137
    v_fmac_f32 v28, v42, v204
    v_fmac_f32 v29, v43, v204
    v_lshlrev_b32 v42, 16, v138
    v_and_b32 v43, 0xffff0000, v138
    v_fmac_f32 v30, v42, v204
    v_fmac_f32 v31, v43, v204
    v_lshlrev_b32 v42, 16, v139
    v_and_b32 v43, 0xffff0000, v139
    v_fmac_f32 v32, v42, v204
    v_fmac_f32 v33, v43, v204
    v_lshlrev_b32 v42, 16, v140
    v_and_b32 v43, 0xffff0000, v140
    v_fmac_f32 v26, v42, v206
    v_fmac_f32 v27, v43, v206
    v_lshlrev_b32 v42, 16, v141
    v_and_b32 v43, 0xffff0000, v141
    v_fmac_f32 v28, v42, v206
    v_fmac_f32 v29, v43, v206
    v_lshlrev_b32 v42, 16, v142
    v_and_b32 v43, 0xffff0000, v142
    v_fmac_f32 v30, v42, v206
    v_fmac_f32 v31, v43, v206
    v_lshlrev_b32 v42, 16, v143
    v_and_b32 v43, 0xffff0000, v143
    v_fmac_f32 v32, v42, v206
    v_fmac_f32 v33, v43, v206
    v_lshlrev_b32 v42, 16, v144
    v_and_b32 v43, 0xffff0000, v144
    v_fmac_f32 v26, v42, v208
    v_fmac_f32 v27, v43, v208
    v_lshlrev_b32 v42, 16, v145
    v_and_b32 v43, 0xffff0000, v145
    v_fmac_f32 v28, v42, v208
    v_fmac_f32 v29, v43, v208
    v_lshlrev_b32 v42, 16, v146
    v_and_b32 v43, 0xffff0000, v146
    v_fmac_f32 v30, v42, v208
    v_fmac_f32 v31, v43, v208
    v_lshlrev_b32 v42, 16, v147
    v_and_b32 v43, 0xffff0000, v147
    v_fmac_f32 v32, v42, v208
    v_fmac_f32 v33, v43, v208
    v_lshlrev_b32 v42, 16, v148
    v_and_b32 v43, 0xffff0000, v148
    v_fmac_f32 v26, v42, v210
    v_fmac_f32 v27, v43, v210
    v_lshlrev_b32 v42, 16, v149
    v_and_b32 v43, 0xffff0000, v149
    v_fmac_f32 v28, v42, v210
    v_fmac_f32 v29, v43, v210
    v_lshlrev_b32 v42, 16, v150
    v_and_b32 v43, 0xffff0000, v150
    v_fmac_f32 v30, v42, v210
    v_fmac_f32 v31, v43, v210
    v_lshlrev_b32 v42, 16, v151
    v_and_b32 v43, 0xffff0000, v151
    v_fmac_f32 v32, v42, v210
    v_fmac_f32 v33, v43, v210
    ds_bpermute_b32 v64, v14, v26
    ds_bpermute_b32 v65, v14, v27
    ds_bpermute_b32 v66, v14, v28
    ds_bpermute_b32 v67, v14, v29
    ds_bpermute_b32 v68, v14, v30
    ds_bpermute_b32 v69, v14, v31
    ds_bpermute_b32 v70, v14, v32
    ds_bpermute_b32 v71, v14, v33
    ds_bpermute_b32 v72, v15, v26
    ds_bpermute_b32 v73, v15, v27
    ds_bpermute_b32 v74, v15, v28
    ds_bpermute_b32 v75, v15, v29
    ds_bpermute_b32 v76, v15, v30
    ds_bpermute_b32 v77, v15, v31
    ds_bpermute_b32 v78, v15, v32
    ds_bpermute_b32 v79, v15, v33
    s_waitcnt lgkmcnt(8)
    v_cndmask_b32 v64, v64, v68, s[64:65]
    v_add_f32 v96, v96, v64
    v_cndmask_b32 v65, v65, v69, s[64:65]
    v_add_f32 v97, v97, v65
    v_cndmask_b32 v66, v66, v70, s[64:65]
    v_add_f32 v98, v98, v66
    v_cndmask_b32 v67, v67, v71, s[64:65]
    v_add_f32 v99, v99, v67
    v_cvt_pk_bf16_f32 v56, v96, v97
    v_cvt_pk_bf16_f32 v57, v98, v99
    buffer_store_dwordx2 v[56:57], v5, s[40:43], 0 offen offset:0 nt
    s_waitcnt lgkmcnt(0)
    v_cndmask_b32 v72, v72, v76, s[64:65]
    v_add_f32 v100, v100, v72
    v_cndmask_b32 v73, v73, v77, s[64:65]
    v_add_f32 v101, v101, v73
    v_cndmask_b32 v74, v74, v78, s[64:65]
    v_add_f32 v102, v102, v74
    v_cndmask_b32 v75, v75, v79, s[64:65]
    v_add_f32 v103, v103, v75
    v_cvt_pk_bf16_f32 v58, v100, v101
    v_cvt_pk_bf16_f32 v59, v102, v103
    buffer_store_dwordx2 v[58:59], v5, s[40:43], 0 offen offset:2048 nt
    s_waitcnt vmcnt(13)
    v_max3_f32 v44, v212, v214, v216
    v_max3_f32 v44, v44, v218, v220
    v_max_f32 v44, v44, v222
    v_sub_f32 v212, v212, v44
    v_sub_f32 v214, v214, v44
    v_sub_f32 v216, v216, v44
    v_sub_f32 v218, v218, v44
    v_sub_f32 v220, v220, v44
    v_sub_f32 v222, v222, v44
    v_exp_f32 v212, v212
    v_exp_f32 v214, v214
    v_exp_f32 v216, v216
    v_exp_f32 v218, v218
    v_exp_f32 v220, v220
    v_exp_f32 v222, v222
    s_nop 0
    v_mul_f32 v45, v212, v213
    v_fmac_f32 v45, v214, v215
    v_fmac_f32 v45, v216, v217
    v_fmac_f32 v45, v218, v219
    v_fmac_f32 v45, v220, v221
    v_fmac_f32 v45, v222, v223
    v_rcp_f32 v45, v45
    s_nop 0
    v_mul_f32 v212, v212, v45
    v_mul_f32 v214, v214, v45
    v_mul_f32 v216, v216, v45
    v_mul_f32 v218, v218, v45
    v_mul_f32 v220, v220, v45
    v_mul_f32 v222, v222, v45
    v_lshlrev_b32 v42, 16, v152
    v_and_b32 v43, 0xffff0000, v152
    v_fmac_f32 v236, v42, v212
    v_fmac_f32 v237, v43, v212
    v_lshlrev_b32 v42, 16, v153
    v_and_b32 v43, 0xffff0000, v153
    v_fmac_f32 v238, v42, v212
    v_fmac_f32 v239, v43, v212
    v_lshlrev_b32 v42, 16, v154
    v_and_b32 v43, 0xffff0000, v154
    v_fmac_f32 v240, v42, v212
    v_fmac_f32 v241, v43, v212
    v_lshlrev_b32 v42, 16, v155
    v_and_b32 v43, 0xffff0000, v155
    v_fmac_f32 v242, v42, v212
    v_fmac_f32 v243, v43, v212
    v_lshlrev_b32 v42, 16, v156
    v_and_b32 v43, 0xffff0000, v156
    v_fmac_f32 v236, v42, v214
    v_fmac_f32 v237, v43, v214
    v_lshlrev_b32 v42, 16, v157
    v_and_b32 v43, 0xffff0000, v157
    v_fmac_f32 v238, v42, v214
    v_fmac_f32 v239, v43, v214
    v_lshlrev_b32 v42, 16, v158
    v_and_b32 v43, 0xffff0000, v158
    v_fmac_f32 v240, v42, v214
    v_fmac_f32 v241, v43, v214
    v_lshlrev_b32 v42, 16, v159
    v_and_b32 v43, 0xffff0000, v159
    v_fmac_f32 v242, v42, v214
    v_fmac_f32 v243, v43, v214
    v_lshlrev_b32 v42, 16, v160
    v_and_b32 v43, 0xffff0000, v160
    v_fmac_f32 v236, v42, v216
    v_fmac_f32 v237, v43, v216
    v_lshlrev_b32 v42, 16, v161
    v_and_b32 v43, 0xffff0000, v161
    v_fmac_f32 v238, v42, v216
    v_fmac_f32 v239, v43, v216
    v_lshlrev_b32 v42, 16, v162
    v_and_b32 v43, 0xffff0000, v162
    v_fmac_f32 v240, v42, v216
    v_fmac_f32 v241, v43, v216
    v_lshlrev_b32 v42, 16, v163
    v_and_b32 v43, 0xffff0000, v163
    v_fmac_f32 v242, v42, v216
    v_fmac_f32 v243, v43, v216
    v_lshlrev_b32 v42, 16, v164
    v_and_b32 v43, 0xffff0000, v164
    v_fmac_f32 v236, v42, v218
    v_fmac_f32 v237, v43, v218
    v_lshlrev_b32 v42, 16, v165
    v_and_b32 v43, 0xffff0000, v165
    v_fmac_f32 v238, v42, v218
    v_fmac_f32 v239, v43, v218
    v_lshlrev_b32 v42, 16, v166
    v_and_b32 v43, 0xffff0000, v166
    v_fmac_f32 v240, v42, v218
    v_fmac_f32 v241, v43, v218
    v_lshlrev_b32 v42, 16, v167
    v_and_b32 v43, 0xffff0000, v167
    v_fmac_f32 v242, v42, v218
    v_fmac_f32 v243, v43, v218
    v_lshlrev_b32 v42, 16, v168
    v_and_b32 v43, 0xffff0000, v168
    v_fmac_f32 v236, v42, v220
    v_fmac_f32 v237, v43, v220
    v_lshlrev_b32 v42, 16, v169
    v_and_b32 v43, 0xffff0000, v169
    v_fmac_f32 v238, v42, v220
    v_fmac_f32 v239, v43, v220
    v_lshlrev_b32 v42, 16, v170
    v_and_b32 v43, 0xffff0000, v170
    v_fmac_f32 v240, v42, v220
    v_fmac_f32 v241, v43, v220
    v_lshlrev_b32 v42, 16, v171
    v_and_b32 v43, 0xffff0000, v171
    v_fmac_f32 v242, v42, v220
    v_fmac_f32 v243, v43, v220
    v_lshlrev_b32 v42, 16, v172
    v_and_b32 v43, 0xffff0000, v172
    v_fmac_f32 v236, v42, v222
    v_fmac_f32 v237, v43, v222
    v_lshlrev_b32 v42, 16, v173
    v_and_b32 v43, 0xffff0000, v173
    v_fmac_f32 v238, v42, v222
    v_fmac_f32 v239, v43, v222
    v_lshlrev_b32 v42, 16, v174
    v_and_b32 v43, 0xffff0000, v174
    v_fmac_f32 v240, v42, v222
    v_fmac_f32 v241, v43, v222
    v_lshlrev_b32 v42, 16, v175
    v_and_b32 v43, 0xffff0000, v175
    v_fmac_f32 v242, v42, v222
    v_fmac_f32 v243, v43, v222
    ds_bpermute_b32 v128, v14, v236
    ds_bpermute_b32 v129, v14, v237
    ds_bpermute_b32 v130, v14, v238
    ds_bpermute_b32 v131, v14, v239
    ds_bpermute_b32 v132, v14, v240
    ds_bpermute_b32 v133, v14, v241
    ds_bpermute_b32 v134, v14, v242
    ds_bpermute_b32 v135, v14, v243
    ds_bpermute_b32 v136, v15, v236
    ds_bpermute_b32 v137, v15, v237
    ds_bpermute_b32 v138, v15, v238
    ds_bpermute_b32 v139, v15, v239
    ds_bpermute_b32 v140, v15, v240
    ds_bpermute_b32 v141, v15, v241
    ds_bpermute_b32 v142, v15, v242
    ds_bpermute_b32 v143, v15, v243
    s_waitcnt lgkmcnt(8)
    v_cndmask_b32 v128, v128, v132, s[64:65]
    v_add_f32 v104, v104, v128
    v_cndmask_b32 v129, v129, v133, s[64:65]
    v_add_f32 v105, v105, v129
    v_cndmask_b32 v130, v130, v134, s[64:65]
    v_add_f32 v106, v106, v130
    v_cndmask_b32 v131, v131, v135, s[64:65]
    v_add_f32 v107, v107, v131
    v_cvt_pk_bf16_f32 v60, v104, v105
    v_cvt_pk_bf16_f32 v61, v106, v107
    buffer_store_dwordx2 v[60:61], v6, s[40:43], 0 offen offset:0 nt
    s_waitcnt lgkmcnt(0)
    v_cndmask_b32 v136, v136, v140, s[64:65]
    v_add_f32 v108, v108, v136
    v_cndmask_b32 v137, v137, v141, s[64:65]
    v_add_f32 v109, v109, v137
    v_cndmask_b32 v138, v138, v142, s[64:65]
    v_add_f32 v110, v110, v138
    v_cndmask_b32 v139, v139, v143, s[64:65]
    v_add_f32 v111, v111, v139
    v_cvt_pk_bf16_f32 v62, v108, v109
    v_cvt_pk_bf16_f32 v63, v110, v111
    buffer_store_dwordx2 v[62:63], v6, s[40:43], 0 offen offset:2048 nt
    s_cmp_gt_u32 s13, 3
    s_cbranch_scc1 L_k2_done
    s_waitcnt vmcnt(4)
    v_max3_f32 v44, v224, v226, v228
    v_max3_f32 v44, v44, v230, v232
    v_max_f32 v44, v44, v234
    v_sub_f32 v224, v224, v44
    v_sub_f32 v226, v226, v44
    v_sub_f32 v228, v228, v44
    v_sub_f32 v230, v230, v44
    v_sub_f32 v232, v232, v44
    v_sub_f32 v234, v234, v44
    v_exp_f32 v224, v224
    v_exp_f32 v226, v226
    v_exp_f32 v228, v228
    v_exp_f32 v230, v230
    v_exp_f32 v232, v232
    v_exp_f32 v234, v234
    s_nop 0
    v_mul_f32 v45, v224, v225
    v_fmac_f32 v45, v226, v227
    v_fmac_f32 v45, v228, v229
    v_fmac_f32 v45, v230, v231
    v_fmac_f32 v45, v232, v233
    v_fmac_f32 v45, v234, v235
    v_rcp_f32 v45, v45
    s_nop 0
    v_mul_f32 v224, v224, v45
    v_mul_f32 v226, v226, v45
    v_mul_f32 v228, v228, v45
    v_mul_f32 v230, v230, v45
    v_mul_f32 v232, v232, v45
    v_mul_f32 v234, v234, v45
    v_lshlrev_b32 v42, 16, v176
    v_and_b32 v43, 0xffff0000, v176
    v_fmac_f32 v244, v42, v224
    v_fmac_f32 v245, v43, v224
    v_lshlrev_b32 v42, 16, v177
    v_and_b32 v43, 0xffff0000, v177
    v_fmac_f32 v246, v42, v224
    v_fmac_f32 v247, v43, v224
    v_lshlrev_b32 v42, 16, v178
    v_and_b32 v43, 0xffff0000, v178
    v_fmac_f32 v248, v42, v224
    v_fmac_f32 v249, v43, v224
    v_lshlrev_b32 v42, 16, v179
    v_and_b32 v43, 0xffff0000, v179
    v_fmac_f32 v250, v42, v224
    v_fmac_f32 v251, v43, v224
    v_lshlrev_b32 v42, 16, v180
    v_and_b32 v43, 0xffff0000, v180
    v_fmac_f32 v244, v42, v226
    v_fmac_f32 v245, v43, v226
    v_lshlrev_b32 v42, 16, v181
    v_and_b32 v43, 0xffff0000, v181
    v_fmac_f32 v246, v42, v226
    v_fmac_f32 v247, v43, v226
    v_lshlrev_b32 v42, 16, v182
    v_and_b32 v43, 0xffff0000, v182
    v_fmac_f32 v248, v42, v226
    v_fmac_f32 v249, v43, v226
    v_lshlrev_b32 v42, 16, v183
    v_and_b32 v43, 0xffff0000, v183
    v_fmac_f32 v250, v42, v226
    v_fmac_f32 v251, v43, v226
    v_lshlrev_b32 v42, 16, v184
    v_and_b32 v43, 0xffff0000, v184
    v_fmac_f32 v244, v42, v228
    v_fmac_f32 v245, v43, v228
    v_lshlrev_b32 v42, 16, v185
    v_and_b32 v43, 0xffff0000, v185
    v_fmac_f32 v246, v42, v228
    v_fmac_f32 v247, v43, v228
    v_lshlrev_b32 v42, 16, v186
    v_and_b32 v43, 0xffff0000, v186
    v_fmac_f32 v248, v42, v228
    v_fmac_f32 v249, v43, v228
    v_lshlrev_b32 v42, 16, v187
    v_and_b32 v43, 0xffff0000, v187
    v_fmac_f32 v250, v42, v228
    v_fmac_f32 v251, v43, v228
    v_lshlrev_b32 v42, 16, v188
    v_and_b32 v43, 0xffff0000, v188
    v_fmac_f32 v244, v42, v230
    v_fmac_f32 v245, v43, v230
    v_lshlrev_b32 v42, 16, v189
    v_and_b32 v43, 0xffff0000, v189
    v_fmac_f32 v246, v42, v230
    v_fmac_f32 v247, v43, v230
    v_lshlrev_b32 v42, 16, v190
    v_and_b32 v43, 0xffff0000, v190
    v_fmac_f32 v248, v42, v230
    v_fmac_f32 v249, v43, v230
    v_lshlrev_b32 v42, 16, v191
    v_and_b32 v43, 0xffff0000, v191
    v_fmac_f32 v250, v42, v230
    v_fmac_f32 v251, v43, v230
    v_lshlrev_b32 v42, 16, v192
    v_and_b32 v43, 0xffff0000, v192
    v_fmac_f32 v244, v42, v232
    v_fmac_f32 v245, v43, v232
    v_lshlrev_b32 v42, 16, v193
    v_and_b32 v43, 0xffff0000, v193
    v_fmac_f32 v246, v42, v232
    v_fmac_f32 v247, v43, v232
    v_lshlrev_b32 v42, 16, v194
    v_and_b32 v43, 0xffff0000, v194
    v_fmac_f32 v248, v42, v232
    v_fmac_f32 v249, v43, v232
    v_lshlrev_b32 v42, 16, v195
    v_and_b32 v43, 0xffff0000, v195
    v_fmac_f32 v250, v42, v232
    v_fmac_f32 v251, v43, v232
    v_lshlrev_b32 v42, 16, v196
    v_and_b32 v43, 0xffff0000, v196
    v_fmac_f32 v244, v42, v234
    v_fmac_f32 v245, v43, v234
    v_lshlrev_b32 v42, 16, v197
    v_and_b32 v43, 0xffff0000, v197
    v_fmac_f32 v246, v42, v234
    v_fmac_f32 v247, v43, v234
    v_lshlrev_b32 v42, 16, v198
    v_and_b32 v43, 0xffff0000, v198
    v_fmac_f32 v248, v42, v234
    v_fmac_f32 v249, v43, v234
    v_lshlrev_b32 v42, 16, v199
    v_and_b32 v43, 0xffff0000, v199
    v_fmac_f32 v250, v42, v234
    v_fmac_f32 v251, v43, v234
    ds_bpermute_b32 v152, v14, v244
    ds_bpermute_b32 v153, v14, v245
    ds_bpermute_b32 v154, v14, v246
    ds_bpermute_b32 v155, v14, v247
    ds_bpermute_b32 v156, v14, v248
    ds_bpermute_b32 v157, v14, v249
    ds_bpermute_b32 v158, v14, v250
    ds_bpermute_b32 v159, v14, v251
    ds_bpermute_b32 v160, v15, v244
    ds_bpermute_b32 v161, v15, v245
    ds_bpermute_b32 v162, v15, v246
    ds_bpermute_b32 v163, v15, v247
    ds_bpermute_b32 v164, v15, v248
    ds_bpermute_b32 v165, v15, v249
    ds_bpermute_b32 v166, v15, v250
    ds_bpermute_b32 v167, v15, v251
    s_waitcnt lgkmcnt(8)
    v_cndmask_b32 v152, v152, v156, s[64:65]
    v_add_f32 v112, v112, v152
    v_cndmask_b32 v153, v153, v157, s[64:65]
    v_add_f32 v113, v113, v153
    v_cndmask_b32 v154, v154, v158, s[64:65]
    v_add_f32 v114, v114, v154
    v_cndmask_b32 v155, v155, v159, s[64:65]
    v_add_f32 v115, v115, v155
    v_cvt_pk_bf16_f32 v46, v112, v113
    v_cvt_pk_bf16_f32 v47, v114, v115
    buffer_store_dwordx2 v[46:47], v7, s[40:43], 0 offen offset:0 nt
    s_waitcnt lgkmcnt(0)
    v_cndmask_b32 v160, v160, v164, s[64:65]
    v_add_f32 v116, v116, v160
    v_cndmask_b32 v161, v161, v165, s[64:65]
    v_add_f32 v117, v117, v161
    v_cndmask_b32 v162, v162, v166, s[64:65]
    v_add_f32 v118, v118, v162
    v_cndmask_b32 v163, v163, v167, s[64:65]
    v_add_f32 v119, v119, v163
    v_cvt_pk_bf16_f32 v48, v116, v117
    v_cvt_pk_bf16_f32 v49, v118, v119
    buffer_store_dwordx2 v[48:49], v7, s[40:43], 0 offen offset:2048 nt
L_k2_done:
    s_waitcnt vmcnt(0)
L_k2_end:
    s_endpgm
L_left:
    v_bfe_u32 v2, v0, 2, 2
    v_and_b32 v3, 3, v0
    v_bfe_u32 v4, v0, 4, 2
    s_lshl_b32 s15, s8, 6
    s_sub_u32 s16, s15, 12
    v_lshlrev_b32 v13, 4, v3
    v_add_u32 v13, s16, v13
    v_lshlrev_b32 v5, 4, v2
    v_sub_u32 v13, v13, v5
    v_lshlrev_b32 v14, 4, v2
    v_lshl_add_u32 v14, v4, 6, v14
    v_add_u32 v14, 131328, v14
    v_add_u32 v14, 3840, v14
L_left_loop:
    ds_read_b128 v[64:67], v14 offset:384
    ds_read_b128 v[68:71], v14 offset:5760
    ds_read_b128 v[72:75], v14 offset:11136
    v_add_u32 v14, 256, v14
    s_waitcnt lgkmcnt(0)
    v_add_u32 v64, v64, v13
    buffer_load_dwordx4 a[128:131], v64, s[44:47], 0 offen offset:12
    v_add_u32 v65, v65, v13
    buffer_load_dwordx4 a[132:135], v65, s[44:47], 0 offen offset:8
    v_add_u32 v66, v66, v13
    buffer_load_dwordx4 a[136:139], v66, s[44:47], 0 offen offset:4
    v_add_u32 v67, v67, v13
    buffer_load_dwordx4 a[140:143], v67, s[44:47], 0 offen offset:0
    v_add_u32 v68, v68, v13
    buffer_load_dwordx4 a[144:147], v68, s[44:47], 0 offen offset:12
    v_add_u32 v69, v69, v13
    buffer_load_dwordx4 a[148:151], v69, s[44:47], 0 offen offset:8
    v_add_u32 v70, v70, v13
    buffer_load_dwordx4 a[152:155], v70, s[44:47], 0 offen offset:4
    v_add_u32 v71, v71, v13
    buffer_load_dwordx4 a[156:159], v71, s[44:47], 0 offen offset:0
    v_add_u32 v72, v72, v13
    buffer_load_dwordx4 a[160:163], v72, s[44:47], 0 offen offset:12
    v_add_u32 v73, v73, v13
    buffer_load_dwordx4 a[164:167], v73, s[44:47], 0 offen offset:8
    v_add_u32 v74, v74, v13
    buffer_load_dwordx4 a[168:171], v74, s[44:47], 0 offen offset:4
    v_add_u32 v75, v75, v13
    buffer_load_dwordx4 a[172:175], v75, s[44:47], 0 offen offset:0
    s_waitcnt vmcnt(0)
    v_mfma_f32_16x16x32_bf16 a[176:179], a[200:203], a[128:131], a[176:179]
    v_mfma_f32_16x16x32_bf16 a[176:179], a[204:207], a[132:135], a[176:179]
    v_mfma_f32_16x16x32_bf16 a[180:183], a[200:203], a[136:139], a[180:183]
    v_mfma_f32_16x16x32_bf16 a[180:183], a[204:207], a[140:143], a[180:183]
    v_mfma_f32_16x16x32_bf16 a[184:187], a[200:203], a[144:147], a[184:187]
    v_mfma_f32_16x16x32_bf16 a[184:187], a[204:207], a[148:151], a[184:187]
    v_mfma_f32_16x16x32_bf16 a[188:191], a[200:203], a[152:155], a[188:191]
    v_mfma_f32_16x16x32_bf16 a[188:191], a[204:207], a[156:159], a[188:191]
    v_mfma_f32_16x16x32_bf16 a[192:195], a[200:203], a[160:163], a[192:195]
    v_mfma_f32_16x16x32_bf16 a[192:195], a[204:207], a[164:167], a[192:195]
    v_mfma_f32_16x16x32_bf16 a[196:199], a[200:203], a[168:171], a[196:199]
    v_mfma_f32_16x16x32_bf16 a[196:199], a[204:207], a[172:175], a[196:199]
    s_sub_u32 s51, s51, 1
    s_cmp_gt_i32 s51, 0
    s_cbranch_scc1 L_left_loop
    s_nop 7
    s_cmp_le_u32 s50, 72
    s_cbranch_scc1 L_left_done
    s_barrier
    s_branch L_car_t
L_left_done:
    v_bfe_u32 v2, v0, 2, 2
    v_bfe_u32 v3, v0, 5, 1
    v_lshl_add_u32 v2, v3, 2, v2
    v_mul_u32_u24 v2, 272, v2
    v_bfe_u32 v3, v0, 1, 1
    v_lshl_add_u32 v2, v3, 5, v2
    v_bfe_u32 v3, v0, 4, 1
    v_lshl_add_u32 v2, v3, 4, v2
    v_and_b32 v3, 1, v0
    v_lshl_add_u32 v2, v3, 3, v2
    s_lshl_b32 s15, s8, 6
    v_add_u32 v2, s15, v2
    v_accvgpr_read_b32 v64, a176
    v_accvgpr_read_b32 v65, a177
    v_accvgpr_read_b32 v66, a178
    v_accvgpr_read_b32 v67, a179
    v_accvgpr_read_b32 v68, a180
    v_accvgpr_read_b32 v69, a181
    v_accvgpr_read_b32 v70, a182
    v_accvgpr_read_b32 v71, a183
    v_accvgpr_read_b32 v72, a184
    v_accvgpr_read_b32 v73, a185
    v_accvgpr_read_b32 v74, a186
    v_accvgpr_read_b32 v75, a187
    v_accvgpr_read_b32 v76, a188
    v_accvgpr_read_b32 v77, a189
    v_accvgpr_read_b32 v78, a190
    v_accvgpr_read_b32 v79, a191
    v_accvgpr_read_b32 v80, a192
    v_accvgpr_read_b32 v81, a193
    v_accvgpr_read_b32 v82, a194
    v_accvgpr_read_b32 v83, a195
    v_accvgpr_read_b32 v84, a196
    v_accvgpr_read_b32 v85, a197
    v_accvgpr_read_b32 v86, a198
    v_accvgpr_read_b32 v87, a199
    v_cvt_pk_bf16_f32 v64, v64, v65
    v_cvt_pk_bf16_f32 v65, v66, v67
    v_cvt_pk_bf16_f32 v66, v68, v69
    v_cvt_pk_bf16_f32 v67, v70, v71
    v_cvt_pk_bf16_f32 v68, v72, v73
    v_cvt_pk_bf16_f32 v69, v74, v75
    v_cvt_pk_bf16_f32 v70, v76, v77
    v_cvt_pk_bf16_f32 v71, v78, v79
    v_cvt_pk_bf16_f32 v72, v80, v81
    v_cvt_pk_bf16_f32 v73, v82, v83
    v_cvt_pk_bf16_f32 v74, v84, v85
    v_cvt_pk_bf16_f32 v75, v86, v87
    ds_write_b64 v2, v[64:65] offset:16384
    ds_write_b64 v2, v[66:67] offset:18560
    ds_write_b64 v2, v[68:69] offset:20736
    ds_write_b64 v2, v[70:71] offset:22912
    ds_write_b64 v2, v[72:73] offset:25088
    ds_write_b64 v2, v[74:75] offset:27264
    s_waitcnt lgkmcnt(0)
    s_barrier
    s_branch L_gdone
L_more2:
    s_barrier
    v_and_b32 v6, 15, v0
    v_bfe_u32 v7, v0, 4, 2
    v_mul_u32_u24 v7, 5376, v7
    v_lshl_add_u32 v7, v6, 2, v7
    v_add_u32 v7, 131328, v7
    ds_read_b32 v9, v7
    s_waitcnt lgkmcnt(0)
    v_max_u32_dpp v9, v9, v9 row_shr:1 row_mask:0xf bank_mask:0xf
    s_nop 1
    v_max_u32_dpp v9, v9, v9 row_shr:2 row_mask:0xf bank_mask:0xf
    s_nop 1
    v_max_u32_dpp v9, v9, v9 row_shr:4 row_mask:0xf bank_mask:0xf
    s_nop 1
    v_max_u32_dpp v9, v9, v9 row_shr:8 row_mask:0xf bank_mask:0xf
    s_nop 1
    v_max_u32_dpp v9, v9, v9 row_bcast:15 row_mask:0xa bank_mask:0xf
    s_nop 1
    v_max_u32_dpp v9, v9, v9 row_bcast:31 row_mask:0xc bank_mask:0xf
    s_nop 1
    v_readlane_b32 s50, v9, 63
    s_nop 3
    s_min_u32 s51, s50, 72
    s_add_u32 s51, s51, 3
    s_lshr_b32 s51, s51, 2
    v_bfe_u32 v2, v0, 2, 2
    v_and_b32 v3, 3, v0
    v_bfe_u32 v4, v0, 4, 2
    s_lshl_b32 s15, s8, 6
    s_sub_u32 s16, s15, 12
    v_lshlrev_b32 v13, 4, v3
    v_add_u32 v13, s16, v13
    v_lshlrev_b32 v5, 4, v2
    v_sub_u32 v13, v13, v5
    v_lshlrev_b32 v14, 4, v2
    v_lshl_add_u32 v14, v4, 6, v14
    v_add_u32 v14, 131328, v14
    s_branch L_left_loop
L_safe:
    s_mov_b32 s11, s17
L_body_s:
    s_waitcnt vmcnt(12)
    s_barrier
    v_mfma_f32_16x16x32_bf16 v[192:195], a[96:99], v[120:123], v[192:195]
    v_exp_f32 v26, v64
    v_mfma_f32_16x16x32_bf16 v[196:199], a[100:103], v[120:123], v[196:199]
    buffer_load_dwordx4 v21, s[80:83], s9 offen offset:0 lds
    v_mfma_f32_16x16x32_bf16 v[200:203], a[104:107], v[120:123], v[200:203]
    v_exp_f32 v27, v65
    v_mfma_f32_16x16x32_bf16 v[204:207], a[108:111], v[120:123], v[204:207]
    buffer_load_dwordx4 v21, s[80:83], s9 offen offset:1024 lds
    v_mfma_f32_16x16x32_bf16 v[208:211], a[112:115], v[120:123], v[208:211]
    v_exp_f32 v28, v66
    v_mfma_f32_16x16x32_bf16 v[212:215], a[116:119], v[120:123], v[212:215]
    v_exp_f32 v29, v67
    v_mfma_f32_16x16x32_bf16 v[216:219], a[120:123], v[120:123], v[216:219]
    v_add_f32 v42, v26, v27
    v_add_f32 v42, v42, v28
    v_mfma_f32_16x16x32_bf16 v[220:223], a[124:127], v[120:123], v[220:223]
    v_exp_f32 v30, v68
    v_mfma_f32_16x16x32_bf16 v[224:227], a[96:99], v[124:127], v[224:227]
    v_exp_f32 v31, v69
    v_mfma_f32_16x16x32_bf16 v[228:231], a[100:103], v[124:127], v[228:231]
    v_add_f32 v42, v42, v29
    v_add_f32 v42, v42, v30
    v_mfma_f32_16x16x32_bf16 v[232:235], a[104:107], v[124:127], v[232:235]
    v_exp_f32 v32, v70
    v_mfma_f32_16x16x32_bf16 v[236:239], a[108:111], v[124:127], v[236:239]
    ds_read_b128 a[96:99], v20 offset:8192
    v_add_f32 v42, v42, v31
    v_mfma_f32_16x16x32_bf16 v[240:243], a[112:115], v[124:127], v[240:243]
    v_exp_f32 v33, v71
    v_mfma_f32_16x16x32_bf16 v[244:247], a[116:119], v[124:127], v[244:247]
    ds_read_b128 a[100:103], v20 offset:9216
    v_add_f32 v42, v42, v32
    v_mfma_f32_16x16x32_bf16 v[248:251], a[120:123], v[124:127], v[248:251]
    v_exp_f32 v34, v72
    v_mfma_f32_16x16x32_bf16 v[252:255], a[124:127], v[124:127], v[252:255]
    ds_read_b128 a[104:107], v20 offset:10240
    v_add_f32 v42, v42, v33
    v_mfma_f32_16x16x32_bf16 v[80:83], a[64:67], a[32:35], v[104:107]
    v_exp_f32 v35, v73
    v_mfma_f32_16x16x32_bf16 v[88:91], a[64:67], a[48:51], v[108:111]
    v_add_f32 v43, v34, v35
    v_cvt_pk_bf16_f32 v112, v26, v27
    v_mfma_f32_16x16x32_bf16 v[84:87], a[80:83], a[32:35], v[104:107]
    v_exp_f32 v36, v74
    v_mfma_f32_16x16x32_bf16 v[92:95], a[80:83], a[48:51], v[108:111]
    ds_read_b128 a[108:111], v20 offset:11264
    v_add_f32 v43, v43, v36
    v_mfma_f32_16x16x32_bf16 v[80:83], a[68:71], a[36:39], v[80:83]
    ds_read_b128 a[112:115], v20 offset:12288
    v_cvt_pk_bf16_f32 v113, v28, v29
    v_mfma_f32_16x16x32_bf16 v[88:91], a[68:71], a[52:55], v[88:91]
    v_exp_f32 v37, v75
    v_mfma_f32_16x16x32_bf16 v[84:87], a[84:87], a[36:39], v[84:87]
    v_add_f32 v43, v43, v37
    v_cvt_pk_bf16_f32 v114, v30, v31
    v_mfma_f32_16x16x32_bf16 v[92:95], a[84:87], a[52:55], v[92:95]
    v_exp_f32 v38, v76
    v_mfma_f32_16x16x32_bf16 v[80:83], a[72:75], a[40:43], v[80:83]
    ds_read_b128 a[116:119], v20 offset:13312
    v_add_f32 v43, v43, v38
    v_mfma_f32_16x16x32_bf16 v[88:91], a[72:75], a[56:59], v[88:91]
    ds_read_b128 a[120:123], v20 offset:14336
    v_cvt_pk_bf16_f32 v115, v32, v33
    v_mfma_f32_16x16x32_bf16 v[84:87], a[88:91], a[40:43], v[84:87]
    ds_read_b128 a[124:127], v20 offset:15360
    v_exp_f32 v39, v77
    v_mfma_f32_16x16x32_bf16 v[92:95], a[88:91], a[56:59], v[92:95]
    v_add_f32 v43, v43, v39
    v_cvt_pk_bf16_f32 v116, v34, v35
    v_mfma_f32_16x16x32_bf16 v[80:83], a[76:79], a[44:47], v[80:83]
    v_exp_f32 v40, v78
    v_mfma_f32_16x16x32_bf16 v[88:91], a[76:79], a[60:63], v[88:91]
    v_add_f32 v43, v43, v40
    v_cvt_pk_bf16_f32 v117, v36, v37
    v_exp_f32 v41, v79
    v_mfma_f32_16x16x32_bf16 v[84:87], a[92:95], a[44:47], v[84:87]
    v_add_f32 v43, v43, v41
    v_cvt_pk_bf16_f32 v118, v38, v39
    v_cvt_pk_bf16_f32 v119, v40, v41
    v_mfma_f32_16x16x32_bf16 v[92:95], a[92:95], a[60:63], v[92:95]
    ds_read_b128 a[64:67], v20 offset:0
    v_max_f32 v22, v42, v43
    v_cmp_lt_f32 vcc, s12, v22
    s_cbranch_vccnz L_slow_sA
L_back_sA:
    s_waitcnt lgkmcnt(1)
    v_mfma_f32_16x16x32_bf16 v[128:131], a[96:99], v[112:115], v[128:131]
    v_exp_f32 v26, v80
    v_mfma_f32_16x16x32_bf16 v[132:135], a[100:103], v[112:115], v[132:135]
    ds_read_b128 a[80:83], v20 offset:4096
    v_add_f32 v52, v52, v42
    v_mfma_f32_16x16x32_bf16 v[136:139], a[104:107], v[112:115], v[136:139]
    buffer_load_dwordx4 v21, s[80:83], s9 offen offset:2048 lds
    v_mfma_f32_16x16x32_bf16 v[140:143], a[108:111], v[112:115], v[140:143]
    v_exp_f32 v27, v81
    v_mfma_f32_16x16x32_bf16 v[144:147], a[112:115], v[112:115], v[144:147]
    buffer_load_dwordx4 v21, s[80:83], s9 offen offset:3072 lds
    v_exp_f32 v28, v82
    v_mfma_f32_16x16x32_bf16 v[148:151], a[116:119], v[112:115], v[148:151]
    ds_read_b128 a[68:71], v20 offset:1024
    v_add_f32 v44, v26, v27
    v_mfma_f32_16x16x32_bf16 v[152:155], a[120:123], v[112:115], v[152:155]
    s_add_u32 s10, s10, 0x4000
    ds_read_b128 a[84:87], v20 offset:5120
    v_add_f32 v44, v44, v28
    v_mfma_f32_16x16x32_bf16 v[156:159], a[124:127], v[112:115], v[156:159]
    s_and_b32 m0, s10, 0x1ffff
    v_exp_f32 v29, v83
    v_mfma_f32_16x16x32_bf16 v[160:163], a[96:99], v[116:119], v[160:163]
    s_add_u32 s9, s9, 0x2000
    ds_read_b128 a[72:75], v20 offset:2048
    v_add_f32 v44, v44, v29
    v_mfma_f32_16x16x32_bf16 v[164:167], a[100:103], v[116:119], v[164:167]
    s_sub_u32 s11, s11, 1
    v_exp_f32 v30, v84
    v_mfma_f32_16x16x32_bf16 v[168:171], a[104:107], v[116:119], v[168:171]
    ds_read_b128 a[88:91], v20 offset:6144
    ds_read_b128 a[76:79], v20 offset:3072
    ds_read_b128 a[92:95], v20 offset:7168
    v_add_f32 v44, v44, v30
    v_mfma_f32_16x16x32_bf16 v[172:175], a[108:111], v[116:119], v[172:175]
    v_exp_f32 v31, v85
    v_mfma_f32_16x16x32_bf16 v[176:179], a[112:115], v[116:119], v[176:179]
    v_exp_f32 v32, v86
    v_mfma_f32_16x16x32_bf16 v[180:183], a[116:119], v[116:119], v[180:183]
    v_add_f32 v44, v44, v31
    v_add_f32 v44, v44, v32
    v_mfma_f32_16x16x32_bf16 v[184:187], a[120:123], v[116:119], v[184:187]
    v_add_f32 v53, v53, v43
    v_exp_f32 v33, v87
    v_mfma_f32_16x16x32_bf16 v[188:191], a[124:127], v[116:119], v[188:191]
    v_add_f32 v44, v44, v33
    v_cvt_pk_bf16_f32 v120, v26, v27
    s_waitcnt lgkmcnt(0)
    v_mfma_f32_16x16x32_bf16 v[64:67], a[64:67], a[0:3], v[96:99]
    v_exp_f32 v34, v88
    v_mfma_f32_16x16x32_bf16 v[72:75], a[64:67], a[16:19], v[100:103]
    v_exp_f32 v35, v89
    v_mfma_f32_16x16x32_bf16 v[68:71], a[80:83], a[0:3], v[96:99]
    v_add_f32 v45, v34, v35
    v_cvt_pk_bf16_f32 v121, v28, v29
    v_mfma_f32_16x16x32_bf16 v[76:79], a[80:83], a[16:19], v[100:103]
    v_exp_f32 v36, v90
    v_mfma_f32_16x16x32_bf16 v[64:67], a[68:71], a[4:7], v[64:67]
    v_add_f32 v45, v45, v36
    v_cvt_pk_bf16_f32 v122, v30, v31
    v_mfma_f32_16x16x32_bf16 v[72:75], a[68:71], a[20:23], v[72:75]
    v_exp_f32 v37, v91
    v_mfma_f32_16x16x32_bf16 v[68:71], a[84:87], a[4:7], v[68:71]
    v_add_f32 v45, v45, v37
    v_cvt_pk_bf16_f32 v123, v32, v33
    v_mfma_f32_16x16x32_bf16 v[76:79], a[84:87], a[20:23], v[76:79]
    v_exp_f32 v38, v92
    v_mfma_f32_16x16x32_bf16 v[64:67], a[72:75], a[8:11], v[64:67]
    v_add_f32 v45, v45, v38
    v_cvt_pk_bf16_f32 v124, v34, v35
    v_mfma_f32_16x16x32_bf16 v[72:75], a[72:75], a[24:27], v[72:75]
    v_exp_f32 v39, v93
    v_mfma_f32_16x16x32_bf16 v[68:71], a[88:91], a[8:11], v[68:71]
    v_add_f32 v45, v45, v39
    v_cvt_pk_bf16_f32 v125, v36, v37
    v_mfma_f32_16x16x32_bf16 v[76:79], a[88:91], a[24:27], v[76:79]
    v_exp_f32 v40, v94
    v_mfma_f32_16x16x32_bf16 v[64:67], a[76:79], a[12:15], v[64:67]
    v_add_f32 v45, v45, v40
    v_cvt_pk_bf16_f32 v126, v38, v39
    v_mfma_f32_16x16x32_bf16 v[72:75], a[76:79], a[28:31], v[72:75]
    v_exp_f32 v41, v95
    v_mfma_f32_16x16x32_bf16 v[68:71], a[92:95], a[12:15], v[68:71]
    s_cmp_lg_u32 s11, 0
    v_add_f32 v45, v45, v41
    v_max_f32 v22, v44, v45
    v_cvt_pk_bf16_f32 v127, v40, v41
    v_mfma_f32_16x16x32_bf16 v[76:79], a[92:95], a[28:31], v[76:79]
    v_cmp_lt_f32 vcc, s12, v22
    v_add_u32 v20, 0x4000, v20
    s_cbranch_vccnz L_slow_sB
L_back_sB:
    v_add_f32 v54, v54, v44
    v_and_b32 v20, 0x1ffff, v20
    v_add_f32 v55, v55, v45
    s_cbranch_scc1 L_body_s
L_body_sf:
    s_waitcnt vmcnt(12)
    s_barrier
    v_mfma_f32_16x16x32_bf16 v[192:195], a[96:99], v[120:123], v[192:195]
    v_exp_f32 v26, v64
    v_mfma_f32_16x16x32_bf16 v[196:199], a[100:103], v[120:123], v[196:199]
    v_exp_f32 v27, v65
    v_mfma_f32_16x16x32_bf16 v[200:203], a[104:107], v[120:123], v[200:203]
    v_exp_f32 v28, v66
    v_mfma_f32_16x16x32_bf16 v[204:207], a[108:111], v[120:123], v[204:207]
    v_exp_f32 v29, v67
    v_mfma_f32_16x16x32_bf16 v[208:211], a[112:115], v[120:123], v[208:211]
    v_add_f32 v42, v26, v27
    v_add_f32 v42, v42, v28
    v_mfma_f32_16x16x32_bf16 v[212:215], a[116:119], v[120:123], v[212:215]
    v_exp_f32 v30, v68
    v_mfma_f32_16x16x32_bf16 v[216:219], a[120:123], v[120:123], v[216:219]
    v_add_f32 v42, v42, v29
    v_add_f32 v42, v42, v30
    v_mfma_f32_16x16x32_bf16 v[220:223], a[124:127], v[120:123], v[220:223]
    v_exp_f32 v31, v69
    v_mfma_f32_16x16x32_bf16 v[224:227], a[96:99], v[124:127], v[224:227]
    v_exp_f32 v32, v70
    v_mfma_f32_16x16x32_bf16 v[228:231], a[100:103], v[124:127], v[228:231]
    ds_read_b128 a[96:99], v20 offset:8192
    v_add_f32 v42, v42, v31
    v_mfma_f32_16x16x32_bf16 v[232:235], a[104:107], v[124:127], v[232:235]
    v_exp_f32 v33, v71
    v_mfma_f32_16x16x32_bf16 v[236:239], a[108:111], v[124:127], v[236:239]
    ds_read_b128 a[100:103], v20 offset:9216
    v_add_f32 v42, v42, v32
    v_mfma_f32_16x16x32_bf16 v[240:243], a[112:115], v[124:127], v[240:243]
    v_exp_f32 v34, v72
    v_mfma_f32_16x16x32_bf16 v[244:247], a[116:119], v[124:127], v[244:247]
    ds_read_b128 a[104:107], v20 offset:10240
    v_add_f32 v42, v42, v33
    v_mfma_f32_16x16x32_bf16 v[248:251], a[120:123], v[124:127], v[248:251]
    v_exp_f32 v35, v73
    v_mfma_f32_16x16x32_bf16 v[252:255], a[124:127], v[124:127], v[252:255]
    v_add_f32 v43, v34, v35
    v_cvt_pk_bf16_f32 v112, v26, v27
    v_mfma_f32_16x16x32_bf16 v[80:83], a[64:67], a[32:35], v[104:107]
    ds_read_b128 a[108:111], v20 offset:11264
    v_cvt_pk_bf16_f32 v113, v28, v29
    v_mfma_f32_16x16x32_bf16 v[88:91], a[64:67], a[48:51], v[108:111]
    v_exp_f32 v36, v74
    v_mfma_f32_16x16x32_bf16 v[84:87], a[80:83], a[32:35], v[104:107]
    ds_read_b128 a[112:115], v20 offset:12288
    v_add_f32 v43, v43, v36
    v_mfma_f32_16x16x32_bf16 v[92:95], a[80:83], a[48:51], v[108:111]
    v_exp_f32 v37, v75
    v_mfma_f32_16x16x32_bf16 v[80:83], a[68:71], a[36:39], v[80:83]
    v_add_f32 v43, v43, v37
    v_cvt_pk_bf16_f32 v114, v30, v31
    v_mfma_f32_16x16x32_bf16 v[88:91], a[68:71], a[52:55], v[88:91]
    ds_read_b128 a[116:119], v20 offset:13312
    v_cvt_pk_bf16_f32 v115, v32, v33
    v_mfma_f32_16x16x32_bf16 v[84:87], a[84:87], a[36:39], v[84:87]
    v_exp_f32 v38, v76
    v_mfma_f32_16x16x32_bf16 v[92:95], a[84:87], a[52:55], v[92:95]
    ds_read_b128 a[120:123], v20 offset:14336
    v_add_f32 v43, v43, v38
    v_mfma_f32_16x16x32_bf16 v[80:83], a[72:75], a[40:43], v[80:83]
    v_exp_f32 v39, v77
    v_mfma_f32_16x16x32_bf16 v[88:91], a[72:75], a[56:59], v[88:91]
    v_add_f32 v43, v43, v39
    v_cvt_pk_bf16_f32 v116, v34, v35
    v_mfma_f32_16x16x32_bf16 v[84:87], a[88:91], a[40:43], v[84:87]
    ds_read_b128 a[124:127], v20 offset:15360
    v_cvt_pk_bf16_f32 v117, v36, v37
    v_mfma_f32_16x16x32_bf16 v[92:95], a[88:91], a[56:59], v[92:95]
    v_exp_f32 v40, v78
    v_mfma_f32_16x16x32_bf16 v[80:83], a[76:79], a[44:47], v[80:83]
    v_add_f32 v43, v43, v40
    v_cvt_pk_bf16_f32 v118, v38, v39
    v_mfma_f32_16x16x32_bf16 v[88:91], a[76:79], a[60:63], v[88:91]
    v_exp_f32 v41, v79
    v_mfma_f32_16x16x32_bf16 v[84:87], a[92:95], a[44:47], v[84:87]
    v_add_f32 v43, v43, v41
    v_max_f32 v22, v42, v43
    v_cvt_pk_bf16_f32 v119, v40, v41
    v_mfma_f32_16x16x32_bf16 v[92:95], a[92:95], a[60:63], v[92:95]
    v_cmp_lt_f32 vcc, s12, v22
    s_cbranch_vccnz L_slow_sfA
L_back_sfA:
    v_add_f32 v52, v52, v42
    s_waitcnt lgkmcnt(0)
    v_mfma_f32_16x16x32_bf16 v[128:131], a[96:99], v[112:115], v[128:131]
    v_exp_f32 v26, v80
    v_mfma_f32_16x16x32_bf16 v[132:135], a[100:103], v[112:115], v[132:135]
    v_exp_f32 v27, v81
    v_mfma_f32_16x16x32_bf16 v[136:139], a[104:107], v[112:115], v[136:139]
    v_exp_f32 v28, v82
    v_mfma_f32_16x16x32_bf16 v[140:143], a[108:111], v[112:115], v[140:143]
    v_exp_f32 v29, v83
    v_mfma_f32_16x16x32_bf16 v[144:147], a[112:115], v[112:115], v[144:147]
    v_exp_f32 v30, v84
    v_mfma_f32_16x16x32_bf16 v[148:151], a[116:119], v[112:115], v[148:151]
    v_exp_f32 v31, v85
    v_mfma_f32_16x16x32_bf16 v[152:155], a[120:123], v[112:115], v[152:155]
    v_exp_f32 v32, v86
    v_mfma_f32_16x16x32_bf16 v[156:159], a[124:127], v[112:115], v[156:159]
    v_add_f32 v44, v26, v27
    v_add_f32 v44, v44, v28
    v_mfma_f32_16x16x32_bf16 v[160:163], a[96:99], v[116:119], v[160:163]
    v_exp_f32 v33, v87
    v_mfma_f32_16x16x32_bf16 v[164:167], a[100:103], v[116:119], v[164:167]
    v_add_f32 v44, v44, v29
    v_add_f32 v44, v44, v30
    v_mfma_f32_16x16x32_bf16 v[168:171], a[104:107], v[116:119], v[168:171]
    v_exp_f32 v34, v88
    v_mfma_f32_16x16x32_bf16 v[172:175], a[108:111], v[116:119], v[172:175]
    v_exp_f32 v35, v89
    v_mfma_f32_16x16x32_bf16 v[176:179], a[112:115], v[116:119], v[176:179]
    v_add_f32 v44, v44, v31
    v_add_f32 v44, v44, v32
    v_mfma_f32_16x16x32_bf16 v[180:183], a[116:119], v[116:119], v[180:183]
    v_exp_f32 v36, v90
    v_exp_f32 v37, v91
    v_exp_f32 v38, v92
    v_exp_f32 v39, v93
    v_exp_f32 v40, v94
    v_exp_f32 v41, v95
    v_mfma_f32_16x16x32_bf16 v[184:187], a[120:123], v[116:119], v[184:187]
    v_add_f32 v44, v44, v33
    v_add_f32 v45, v34, v35
    v_add_f32 v45, v45, v36
    v_add_f32 v45, v45, v37
    v_cvt_pk_bf16_f32 v120, v26, v27
    v_add_f32 v45, v45, v38
    v_cvt_pk_bf16_f32 v121, v28, v29
    v_add_f32 v45, v45, v39
    v_cvt_pk_bf16_f32 v122, v30, v31
    v_add_f32 v45, v45, v40
    v_cvt_pk_bf16_f32 v123, v32, v33
    v_add_f32 v45, v45, v41
    v_cvt_pk_bf16_f32 v124, v34, v35
    v_cvt_pk_bf16_f32 v125, v36, v37
    v_cvt_pk_bf16_f32 v126, v38, v39
    v_add_f32 v53, v53, v43
    v_cvt_pk_bf16_f32 v127, v40, v41
    v_mfma_f32_16x16x32_bf16 v[188:191], a[124:127], v[116:119], v[188:191]
    v_max_f32 v22, v44, v45
    v_cmp_lt_f32 vcc, s12, v22
    s_cbranch_vccnz L_slow_sfB
L_back_sfB:
    v_add_f32 v54, v54, v44
    v_add_f32 v55, v55, v45
    s_nop 1
    v_mfma_f32_16x16x32_bf16 v[192:195], a[96:99], v[120:123], v[192:195]
    v_cvt_pk_bf16_f32 v26, v128, v129
    v_cvt_pk_bf16_f32 v27, v130, v131
    v_mfma_f32_16x16x32_bf16 v[196:199], a[100:103], v[120:123], v[196:199]
    v_cvt_pk_bf16_f32 v28, v132, v133
    v_cvt_pk_bf16_f32 v29, v134, v135
    buffer_store_dwordx4 v[26:29], v21, s[4:7], s56 offen offset:0 sc1
    v_mfma_f32_16x16x32_bf16 v[200:203], a[104:107], v[120:123], v[200:203]
    v_cvt_pk_bf16_f32 v30, v136, v137
    v_cvt_pk_bf16_f32 v31, v138, v139
    v_mfma_f32_16x16x32_bf16 v[204:207], a[108:111], v[120:123], v[204:207]
    v_cvt_pk_bf16_f32 v32, v140, v141
    v_cvt_pk_bf16_f32 v33, v142, v143
    buffer_store_dwordx4 v[30:33], v21, s[4:7], s56 offen offset:1024 sc1
    v_mfma_f32_16x16x32_bf16 v[208:211], a[112:115], v[120:123], v[208:211]
    v_cvt_pk_bf16_f32 v26, v144, v145
    v_cvt_pk_bf16_f32 v27, v146, v147
    v_mfma_f32_16x16x32_bf16 v[212:215], a[116:119], v[120:123], v[212:215]
    v_cvt_pk_bf16_f32 v28, v148, v149
    v_cvt_pk_bf16_f32 v29, v150, v151
    buffer_store_dwordx4 v[26:29], v21, s[4:7], s56 offen offset:2048 sc1
    v_mfma_f32_16x16x32_bf16 v[216:219], a[120:123], v[120:123], v[216:219]
    v_cvt_pk_bf16_f32 v30, v152, v153
    v_cvt_pk_bf16_f32 v31, v154, v155
    v_mfma_f32_16x16x32_bf16 v[220:223], a[124:127], v[120:123], v[220:223]
    v_cvt_pk_bf16_f32 v32, v156, v157
    v_cvt_pk_bf16_f32 v33, v158, v159
    buffer_store_dwordx4 v[30:33], v21, s[4:7], s56 offen offset:3072 sc1
    v_mfma_f32_16x16x32_bf16 v[224:227], a[96:99], v[124:127], v[224:227]
    v_cvt_pk_bf16_f32 v26, v160, v161
    v_cvt_pk_bf16_f32 v27, v162, v163
    v_mfma_f32_16x16x32_bf16 v[228:231], a[100:103], v[124:127], v[228:231]
    v_cvt_pk_bf16_f32 v28, v164, v165
    v_cvt_pk_bf16_f32 v29, v166, v167
    buffer_store_dwordx4 v[26:29], v21, s[4:7], s57 offen offset:0 sc1
    v_mfma_f32_16x16x32_bf16 v[232:235], a[104:107], v[124:127], v[232:235]
    v_cvt_pk_bf16_f32 v30, v168, v169
    v_cvt_pk_bf16_f32 v31, v170, v171
    v_mfma_f32_16x16x32_bf16 v[236:239], a[108:111], v[124:127], v[236:239]
    v_cvt_pk_bf16_f32 v32, v172, v173
    v_cvt_pk_bf16_f32 v33, v174, v175
    buffer_store_dwordx4 v[30:33], v21, s[4:7], s57 offen offset:1024 sc1
    v_mfma_f32_16x16x32_bf16 v[240:243], a[112:115], v[124:127], v[240:243]
    v_cvt_pk_bf16_f32 v26, v176, v177
    v_cvt_pk_bf16_f32 v27, v178, v179
    v_mfma_f32_16x16x32_bf16 v[244:247], a[116:119], v[124:127], v[244:247]
    v_cvt_pk_bf16_f32 v28, v180, v181
    v_cvt_pk_bf16_f32 v29, v182, v183
    buffer_store_dwordx4 v[26:29], v21, s[4:7], s57 offen offset:2048 sc1
    v_mfma_f32_16x16x32_bf16 v[248:251], a[120:123], v[124:127], v[248:251]
    v_cvt_pk_bf16_f32 v30, v184, v185
    v_cvt_pk_bf16_f32 v31, v186, v187
    v_mfma_f32_16x16x32_bf16 v[252:255], a[124:127], v[124:127], v[252:255]
    v_cvt_pk_bf16_f32 v32, v188, v189
    v_cvt_pk_bf16_f32 v33, v190, v191
    buffer_store_dwordx4 v[30:33], v21, s[4:7], s57 offen offset:3072 sc1
    s_branch L_k2_chk
L_redo:
    s_waitcnt vmcnt(0)
    s_barrier
    s_mov_b32 s30, 1
    s_branch L_k2_restart
L_own:
    s_ff1_i32_b32 s16, s15
    s_lshl_b32 s52, s8, 2
    s_add_u32 s52, s52, s16
    s_sub_u32 s52, s52, s13
    s_mul_i32 s52, s52, 683
    s_and_b32 s52, s52, 0x3000
    v_add_u32 v42, s52, v21
    s_cmp_eq_u32 s16, 1
    s_cbranch_scc1 L_own1
    s_cmp_eq_u32 s16, 2
    s_cbranch_scc1 L_own2
    s_cmp_eq_u32 s16, 3
    s_cbranch_scc1 L_own3
L_own0:
    v_cvt_pk_bf16_f32 v26, v128, v129
    v_cvt_pk_bf16_f32 v27, v130, v131
    v_cvt_pk_bf16_f32 v28, v132, v133
    v_cvt_pk_bf16_f32 v29, v134, v135
    ds_write_b128 v42, v[26:29] offset:0
    v_cvt_pk_bf16_f32 v30, v136, v137
    v_cvt_pk_bf16_f32 v31, v138, v139
    v_cvt_pk_bf16_f32 v32, v140, v141
    v_cvt_pk_bf16_f32 v33, v142, v143
    ds_write_b128 v42, v[30:33] offset:1024
    v_cvt_pk_bf16_f32 v34, v144, v145
    v_cvt_pk_bf16_f32 v35, v146, v147
    v_cvt_pk_bf16_f32 v36, v148, v149
    v_cvt_pk_bf16_f32 v37, v150, v151
    ds_write_b128 v42, v[34:37] offset:2048
    v_cvt_pk_bf16_f32 v38, v152, v153
    v_cvt_pk_bf16_f32 v39, v154, v155
    v_cvt_pk_bf16_f32 v40, v156, v157
    v_cvt_pk_bf16_f32 v41, v158, v159
    ds_write_b128 v42, v[38:41] offset:3072
    s_branch L_ownr
L_own1:
    v_cvt_pk_bf16_f32 v26, v160, v161
    v_cvt_pk_bf16_f32 v27, v162, v163
    v_cvt_pk_bf16_f32 v28, v164, v165
    v_cvt_pk_bf16_f32 v29, v166, v167
    ds_write_b128 v42, v[26:29] offset:0
    v_cvt_pk_bf16_f32 v30, v168, v169
    v_cvt_pk_bf16_f32 v31, v170, v171
    v_cvt_pk_bf16_f32 v32, v172, v173
    v_cvt_pk_bf16_f32 v33, v174, v175
    ds_write_b128 v42, v[30:33] offset:1024
    v_cvt_pk_bf16_f32 v34, v176, v177
    v_cvt_pk_bf16_f32 v35, v178, v179
    v_cvt_pk_bf16_f32 v36, v180, v181
    v_cvt_pk_bf16_f32 v37, v182, v183
    ds_write_b128 v42, v[34:37] offset:2048
    v_cvt_pk_bf16_f32 v38, v184, v185
    v_cvt_pk_bf16_f32 v39, v186, v187
    v_cvt_pk_bf16_f32 v40, v188, v189
    v_cvt_pk_bf16_f32 v41, v190, v191
    ds_write_b128 v42, v[38:41] offset:3072
    s_branch L_ownr
L_own2:
    v_cvt_pk_bf16_f32 v26, v192, v193
    v_cvt_pk_bf16_f32 v27, v194, v195
    v_cvt_pk_bf16_f32 v28, v196, v197
    v_cvt_pk_bf16_f32 v29, v198, v199
    ds_write_b128 v42, v[26:29] offset:0
    v_cvt_pk_bf16_f32 v30, v200, v201
    v_cvt_pk_bf16_f32 v31, v202, v203
    v_cvt_pk_bf16_f32 v32, v204, v205
    v_cvt_pk_bf16_f32 v33, v206, v207
    ds_write_b128 v42, v[30:33] offset:1024
    v_cvt_pk_bf16_f32 v34, v208, v209
    v_cvt_pk_bf16_f32 v35, v210, v211
    v_cvt_pk_bf16_f32 v36, v212, v213
    v_cvt_pk_bf16_f32 v37, v214, v215
    ds_write_b128 v42, v[34:37] offset:2048
    v_cvt_pk_bf16_f32 v38, v216, v217
    v_cvt_pk_bf16_f32 v39, v218, v219
    v_cvt_pk_bf16_f32 v40, v220, v221
    v_cvt_pk_bf16_f32 v41, v222, v223
    ds_write_b128 v42, v[38:41] offset:3072
    s_branch L_ownr
L_own3:
    v_cvt_pk_bf16_f32 v26, v224, v225
    v_cvt_pk_bf16_f32 v27, v226, v227
    v_cvt_pk_bf16_f32 v28, v228, v229
    v_cvt_pk_bf16_f32 v29, v230, v231
    ds_write_b128 v42, v[26:29] offset:0
    v_cvt_pk_bf16_f32 v30, v232, v233
    v_cvt_pk_bf16_f32 v31, v234, v235
    v_cvt_pk_bf16_f32 v32, v236, v237
    v_cvt_pk_bf16_f32 v33, v238, v239
    ds_write_b128 v42, v[30:33] offset:1024
    v_cvt_pk_bf16_f32 v34, v240, v241
    v_cvt_pk_bf16_f32 v35, v242, v243
    v_cvt_pk_bf16_f32 v36, v244, v245
    v_cvt_pk_bf16_f32 v37, v246, v247
    ds_write_b128 v42, v[34:37] offset:2048
    v_cvt_pk_bf16_f32 v38, v248, v249
    v_cvt_pk_bf16_f32 v39, v250, v251
    v_cvt_pk_bf16_f32 v40, v252, v253
    v_cvt_pk_bf16_f32 v41, v254, v255
    ds_write_b128 v42, v[38:41] offset:3072
    s_branch L_ownr
L_lo:
    s_cmp_eq_u32 s13, 1
    s_cbranch_scc1 L_lo1
    v_sub_f32 v84, v84, v28
    v_sub_f32 v85, v85, v28
    v_sub_f32 v86, v86, v28
    v_sub_f32 v87, v87, v28
    v_sub_f32 v92, v92, v29
    v_sub_f32 v93, v93, v29
    v_sub_f32 v94, v94, v29
    v_sub_f32 v95, v95, v29
    v_exp_f32 v84, v84
    v_exp_f32 v85, v85
    v_exp_f32 v86, v86
    v_exp_f32 v87, v87
    v_exp_f32 v92, v92
    v_exp_f32 v93, v93
    v_exp_f32 v94, v94
    v_exp_f32 v95, v95
    v_add_f32 v54, v84, v85
    v_cvt_pk_bf16_f32 v120, v84, v85
    v_add_f32 v54, v54, v86
    v_cvt_pk_bf16_f32 v121, v86, v87
    v_add_f32 v54, v54, v87
    v_add_f32 v55, v92, v93
    v_cvt_pk_bf16_f32 v124, v92, v93
    v_add_f32 v55, v55, v94
    v_cvt_pk_bf16_f32 v125, v94, v95
    v_add_f32 v55, v55, v95
    s_branch L_lo_ret
L_lo1:
    v_mov_b32 v114, 0
    v_mov_b32 v115, 0
    v_mov_b32 v118, 0
    v_mov_b32 v119, 0
    v_sub_f32 v68, v68, v26
    v_sub_f32 v69, v69, v26
    v_sub_f32 v70, v70, v26
    v_sub_f32 v71, v71, v26
    v_sub_f32 v76, v76, v27
    v_sub_f32 v77, v77, v27
    v_sub_f32 v78, v78, v27
    v_sub_f32 v79, v79, v27
    v_exp_f32 v68, v68
    v_exp_f32 v69, v69
    v_exp_f32 v70, v70
    v_exp_f32 v71, v71
    v_exp_f32 v76, v76
    v_exp_f32 v77, v77
    v_exp_f32 v78, v78
    v_exp_f32 v79, v79
    v_add_f32 v52, v68, v69
    v_cvt_pk_bf16_f32 v112, v68, v69
    v_add_f32 v52, v52, v70
    v_cvt_pk_bf16_f32 v113, v70, v71
    v_add_f32 v52, v52, v71
    v_add_f32 v53, v76, v77
    v_cvt_pk_bf16_f32 v116, v76, v77
    v_add_f32 v53, v53, v78
    v_cvt_pk_bf16_f32 v117, v78, v79
    v_add_f32 v53, v53, v79
    s_waitcnt vmcnt(8)
    v_mfma_f32_16x16x32_bf16 v[128:131], a[96:99], v[112:115], v[128:131]
    v_mfma_f32_16x16x32_bf16 v[132:135], a[100:103], v[112:115], v[132:135]
    v_mfma_f32_16x16x32_bf16 v[136:139], a[104:107], v[112:115], v[136:139]
    v_mfma_f32_16x16x32_bf16 v[140:143], a[108:111], v[112:115], v[140:143]
    v_mfma_f32_16x16x32_bf16 v[144:147], a[112:115], v[112:115], v[144:147]
    v_mfma_f32_16x16x32_bf16 v[148:151], a[116:119], v[112:115], v[148:151]
    v_mfma_f32_16x16x32_bf16 v[152:155], a[120:123], v[112:115], v[152:155]
    v_mfma_f32_16x16x32_bf16 v[156:159], a[124:127], v[112:115], v[156:159]
    v_mfma_f32_16x16x32_bf16 v[160:163], a[96:99], v[116:119], v[160:163]
    v_mfma_f32_16x16x32_bf16 v[164:167], a[100:103], v[116:119], v[164:167]
    v_mfma_f32_16x16x32_bf16 v[168:171], a[104:107], v[116:119], v[168:171]
    v_mfma_f32_16x16x32_bf16 v[172:175], a[108:111], v[116:119], v[172:175]
    v_mfma_f32_16x16x32_bf16 v[176:179], a[112:115], v[116:119], v[176:179]
    v_mfma_f32_16x16x32_bf16 v[180:183], a[116:119], v[116:119], v[180:183]
    v_mfma_f32_16x16x32_bf16 v[184:187], a[120:123], v[116:119], v[184:187]
    v_mfma_f32_16x16x32_bf16 v[188:191], a[124:127], v[116:119], v[188:191]
    s_branch L_lo_ret
L_car_e:
    s_nop 7
    v_and_b32 v2, 63, v0
    v_and_b32 v3, 15, v0
    v_lshl_add_u32 v3, v3, 2, v17
    v_mov_b32 v4, 0
    v_lshl_add_u32 v5, v2, 4, v17
    ds_write_b32 v3, v4
    v_mov_b32 v4, 0x40000000
    ds_write_b32 v16, v4
    v_mov_b32 v6, 2147483392
    v_mov_b32 v7, 2147483392
    v_mov_b32 v8, 2147483392
    v_mov_b32 v9, 2147483392
    v_lshl_add_u32 v3, v2, 3, v17
    ds_write_b128 v5, v[6:9] offset:384
    ds_write_b128 v5, v[6:9] offset:1408
    ds_write_b128 v5, v[6:9] offset:2432
    ds_write_b128 v5, v[6:9] offset:3456
    ds_write_b64 v3, v[6:7] offset:4480
    v_mov_b32 v10, 1
    s_mov_b64 s[66:67], -1
    s_waitcnt lgkmcnt(0)
L_car_loop_e:
    buffer_load_dwordx4 v[26:29], v51, s[4:7], s48 offen
    s_waitcnt vmcnt(0)
    v_cmp_lt_u32 vcc, 0, v50
    v_and_or_b32 v56, v26, 60, v17
    s_nop 0
    s_and_b64 vcc, vcc, s[66:67]
    s_nop 0
    v_cndmask_b32 v56, v16, v56, vcc
    ds_add_rtn_u32 v57, v56, v10
    s_waitcnt lgkmcnt(0)
    v_cmp_gt_u32 s[66:67], s49, v57
    v_min_u32 v57, s49, v57
    v_lshl_add_u32 v56, v57, 6, v56
    ds_write_b32 v56, v26 offset:384
    v_cndmask_b32 v57, 0, v10, s[66:67]
    v_sub_u32 v50, v50, v57
    v_lshl_add_u32 v51, v57, 2, v51
    v_cmp_lt_u32 vcc, 0, v50
    v_and_or_b32 v56, v27, 60, v17
    s_nop 0
    s_and_b64 vcc, vcc, s[66:67]
    s_nop 0
    v_cndmask_b32 v56, v16, v56, vcc
    ds_add_rtn_u32 v57, v56, v10
    s_waitcnt lgkmcnt(0)
    v_cmp_gt_u32 s[66:67], s49, v57
    v_min_u32 v57, s49, v57
    v_lshl_add_u32 v56, v57, 6, v56
    ds_write_b32 v56, v27 offset:384
    v_cndmask_b32 v57, 0, v10, s[66:67]
    v_sub_u32 v50, v50, v57
    v_lshl_add_u32 v51, v57, 2, v51
    v_cmp_lt_u32 vcc, 0, v50
    v_and_or_b32 v56, v28, 60, v17
    s_nop 0
    s_and_b64 vcc, vcc, s[66:67]
    s_nop 0
    v_cndmask_b32 v56, v16, v56, vcc
    ds_add_rtn_u32 v57, v56, v10
    s_waitcnt lgkmcnt(0)
    v_cmp_gt_u32 s[66:67], s49, v57
    v_min_u32 v57, s49, v57
    v_lshl_add_u32 v56, v57, 6, v56
    ds_write_b32 v56, v28 offset:384
    v_cndmask_b32 v57, 0, v10, s[66:67]
    v_sub_u32 v50, v50, v57
    v_lshl_add_u32 v51, v57, 2, v51
    v_cmp_lt_u32 vcc, 0, v50
    v_and_or_b32 v56, v29, 60, v17
    s_nop 0
    s_and_b64 vcc, vcc, s[66:67]
    s_nop 0
    v_cndmask_b32 v56, v16, v56, vcc
    ds_add_rtn_u32 v57, v56, v10
    s_waitcnt lgkmcnt(0)
    v_cmp_gt_u32 s[66:67], s49, v57
    v_min_u32 v57, s49, v57
    v_lshl_add_u32 v56, v57, 6, v56
    ds_write_b32 v56, v29 offset:384
    v_cndmask_b32 v57, 0, v10, s[66:67]
    v_sub_u32 v50, v50, v57
    v_lshl_add_u32 v51, v57, 2, v51
    s_cmp_lg_u64 s[66:67], 0
    s_cbranch_scc1 L_car_loop_e
    s_waitcnt lgkmcnt(0)
    s_branch L_ev_ret
L_car_t:
    s_nop 7
    v_and_b32 v2, 63, v0
    v_and_b32 v3, 15, v0
    v_lshl_add_u32 v3, v3, 2, v17
    v_mov_b32 v4, 0
    v_lshl_add_u32 v5, v2, 4, v17
    ds_write_b32 v3, v4
    v_mov_b32 v4, 0x40000000
    ds_write_b32 v16, v4
    v_mov_b32 v6, 2147483392
    v_mov_b32 v7, 2147483392
    v_mov_b32 v8, 2147483392
    v_mov_b32 v9, 2147483392
    v_lshl_add_u32 v3, v2, 3, v17
    ds_write_b128 v5, v[6:9] offset:384
    ds_write_b128 v5, v[6:9] offset:1408
    ds_write_b128 v5, v[6:9] offset:2432
    ds_write_b128 v5, v[6:9] offset:3456
    ds_write_b64 v3, v[6:7] offset:4480
    v_mov_b32 v10, 1
    s_mov_b64 s[66:67], -1
    s_waitcnt lgkmcnt(0)
L_car_loop_t:
    buffer_load_dwordx4 v[26:29], v51, s[4:7], s48 offen
    s_waitcnt vmcnt(0)
    v_cmp_lt_u32 vcc, 0, v50
    v_and_or_b32 v56, v26, 60, v17
    s_nop 0
    s_and_b64 vcc, vcc, s[66:67]
    s_nop 0
    v_cndmask_b32 v56, v16, v56, vcc
    ds_add_rtn_u32 v57, v56, v10
    s_waitcnt lgkmcnt(0)
    v_cmp_gt_u32 s[66:67], s49, v57
    v_min_u32 v57, s49, v57
    v_lshl_add_u32 v56, v57, 6, v56
    ds_write_b32 v56, v26 offset:384
    v_cndmask_b32 v57, 0, v10, s[66:67]
    v_sub_u32 v50, v50, v57
    v_lshl_add_u32 v51, v57, 2, v51
    v_cmp_lt_u32 vcc, 0, v50
    v_and_or_b32 v56, v27, 60, v17
    s_nop 0
    s_and_b64 vcc, vcc, s[66:67]
    s_nop 0
    v_cndmask_b32 v56, v16, v56, vcc
    ds_add_rtn_u32 v57, v56, v10
    s_waitcnt lgkmcnt(0)
    v_cmp_gt_u32 s[66:67], s49, v57
    v_min_u32 v57, s49, v57
    v_lshl_add_u32 v56, v57, 6, v56
    ds_write_b32 v56, v27 offset:384
    v_cndmask_b32 v57, 0, v10, s[66:67]
    v_sub_u32 v50, v50, v57
    v_lshl_add_u32 v51, v57, 2, v51
    v_cmp_lt_u32 vcc, 0, v50
    v_and_or_b32 v56, v28, 60, v17
    s_nop 0
    s_and_b64 vcc, vcc, s[66:67]
    s_nop 0
    v_cndmask_b32 v56, v16, v56, vcc
    ds_add_rtn_u32 v57, v56, v10
    s_waitcnt lgkmcnt(0)
    v_cmp_gt_u32 s[66:67], s49, v57
    v_min_u32 v57, s49, v57
    v_lshl_add_u32 v56, v57, 6, v56
    ds_write_b32 v56, v28 offset:384
    v_cndmask_b32 v57, 0, v10, s[66:67]
    v_sub_u32 v50, v50, v57
    v_lshl_add_u32 v51, v57, 2, v51
    v_cmp_lt_u32 vcc, 0, v50
    v_and_or_b32 v56, v29, 60, v17
    s_nop 0
    s_and_b64 vcc, vcc, s[66:67]
    s_nop 0
    v_cndmask_b32 v56, v16, v56, vcc
    ds_add_rtn_u32 v57, v56, v10
    s_waitcnt lgkmcnt(0)
    v_cmp_gt_u32 s[66:67], s49, v57
    v_min_u32 v57, s49, v57
    v_lshl_add_u32 v56, v57, 6, v56
    ds_write_b32 v56, v29 offset:384
    v_cndmask_b32 v57, 0, v10, s[66:67]
    v_sub_u32 v50, v50, v57
    v_lshl_add_u32 v51, v57, 2, v51
    s_cmp_lg_u64 s[66:67], 0
    s_cbranch_scc1 L_car_loop_t
    s_waitcnt lgkmcnt(0)
    s_branch L_more2
L_slow_sA:
    s_nop 15
    v_max3_f32 v22, v64, v65, v66
    v_max3_f32 v22, v22, v67, v68
    v_max3_f32 v22, v22, v69, v70
    v_max_f32 v22, v22, v71
    v_mov_b32 v24, v22
    s_nop 1
    v_permlane32_swap_b32 v22, v24
    s_nop 1
    v_max_f32 v22, v22, v24
    v_mov_b32 v24, v22
    s_nop 1
    v_permlane16_swap_b32 v22, v24
    s_nop 1
    v_max_f32 v22, v22, v24
    v_max_f32 v22, 0, v22
    v_exp_f32 v23, -v22
    s_nop 0
    v_mul_f32 v52, v52, v23
    v_mul_f32 v128, v128, v23
    v_mul_f32 v129, v129, v23
    v_mul_f32 v130, v130, v23
    v_mul_f32 v131, v131, v23
    v_mul_f32 v132, v132, v23
    v_mul_f32 v133, v133, v23
    v_mul_f32 v134, v134, v23
    v_mul_f32 v135, v135, v23
    v_mul_f32 v136, v136, v23
    v_mul_f32 v137, v137, v23
    v_mul_f32 v138, v138, v23
    v_mul_f32 v139, v139, v23
    v_mul_f32 v140, v140, v23
    v_mul_f32 v141, v141, v23
    v_mul_f32 v142, v142, v23
    v_mul_f32 v143, v143, v23
    v_mul_f32 v144, v144, v23
    v_mul_f32 v145, v145, v23
    v_mul_f32 v146, v146, v23
    v_mul_f32 v147, v147, v23
    v_mul_f32 v148, v148, v23
    v_mul_f32 v149, v149, v23
    v_mul_f32 v150, v150, v23
    v_mul_f32 v151, v151, v23
    v_mul_f32 v152, v152, v23
    v_mul_f32 v153, v153, v23
    v_mul_f32 v154, v154, v23
    v_mul_f32 v155, v155, v23
    v_mul_f32 v156, v156, v23
    v_mul_f32 v157, v157, v23
    v_mul_f32 v158, v158, v23
    v_mul_f32 v159, v159, v23
    v_sub_f32 v96, v96, v22
    v_sub_f32 v97, v97, v22
    v_sub_f32 v98, v98, v22
    v_sub_f32 v99, v99, v22
    v_sub_f32 v64, v64, v22
    v_sub_f32 v65, v65, v22
    v_exp_f32 v26, v64
    v_exp_f32 v27, v65
    s_nop 0
    v_add_f32 v42, v26, v27
    v_cvt_pk_bf16_f32 v112, v26, v27
    v_sub_f32 v66, v66, v22
    v_sub_f32 v67, v67, v22
    v_exp_f32 v26, v66
    v_exp_f32 v27, v67
    s_nop 0
    v_add_f32 v42, v42, v26
    v_add_f32 v42, v42, v27
    v_cvt_pk_bf16_f32 v113, v26, v27
    v_sub_f32 v68, v68, v22
    v_sub_f32 v69, v69, v22
    v_exp_f32 v26, v68
    v_exp_f32 v27, v69
    s_nop 0
    v_add_f32 v42, v42, v26
    v_add_f32 v42, v42, v27
    v_cvt_pk_bf16_f32 v114, v26, v27
    v_sub_f32 v70, v70, v22
    v_sub_f32 v71, v71, v22
    v_exp_f32 v26, v70
    v_exp_f32 v27, v71
    s_nop 0
    v_add_f32 v42, v42, v26
    v_add_f32 v42, v42, v27
    v_cvt_pk_bf16_f32 v115, v26, v27
    v_max3_f32 v22, v72, v73, v74
    v_max3_f32 v22, v22, v75, v76
    v_max3_f32 v22, v22, v77, v78
    v_max_f32 v22, v22, v79
    v_mov_b32 v24, v22
    s_nop 1
    v_permlane32_swap_b32 v22, v24
    s_nop 1
    v_max_f32 v22, v22, v24
    v_mov_b32 v24, v22
    s_nop 1
    v_permlane16_swap_b32 v22, v24
    s_nop 1
    v_max_f32 v22, v22, v24
    v_max_f32 v22, 0, v22
    v_exp_f32 v23, -v22
    s_nop 0
    v_mul_f32 v53, v53, v23
    v_mul_f32 v160, v160, v23
    v_mul_f32 v161, v161, v23
    v_mul_f32 v162, v162, v23
    v_mul_f32 v163, v163, v23
    v_mul_f32 v164, v164, v23
    v_mul_f32 v165, v165, v23
    v_mul_f32 v166, v166, v23
    v_mul_f32 v167, v167, v23
    v_mul_f32 v168, v168, v23
    v_mul_f32 v169, v169, v23
    v_mul_f32 v170, v170, v23
    v_mul_f32 v171, v171, v23
    v_mul_f32 v172, v172, v23
    v_mul_f32 v173, v173, v23
    v_mul_f32 v174, v174, v23
    v_mul_f32 v175, v175, v23
    v_mul_f32 v176, v176, v23
    v_mul_f32 v177, v177, v23
    v_mul_f32 v178, v178, v23
    v_mul_f32 v179, v179, v23
    v_mul_f32 v180, v180, v23
    v_mul_f32 v181, v181, v23
    v_mul_f32 v182, v182, v23
    v_mul_f32 v183, v183, v23
    v_mul_f32 v184, v184, v23
    v_mul_f32 v185, v185, v23
    v_mul_f32 v186, v186, v23
    v_mul_f32 v187, v187, v23
    v_mul_f32 v188, v188, v23
    v_mul_f32 v189, v189, v23
    v_mul_f32 v190, v190, v23
    v_mul_f32 v191, v191, v23
    v_sub_f32 v100, v100, v22
    v_sub_f32 v101, v101, v22
    v_sub_f32 v102, v102, v22
    v_sub_f32 v103, v103, v22
    v_sub_f32 v72, v72, v22
    v_sub_f32 v73, v73, v22
    v_exp_f32 v26, v72
    v_exp_f32 v27, v73
    s_nop 0
    v_add_f32 v43, v26, v27
    v_cvt_pk_bf16_f32 v116, v26, v27
    v_sub_f32 v74, v74, v22
    v_sub_f32 v75, v75, v22
    v_exp_f32 v26, v74
    v_exp_f32 v27, v75
    s_nop 0
    v_add_f32 v43, v43, v26
    v_add_f32 v43, v43, v27
    v_cvt_pk_bf16_f32 v117, v26, v27
    v_sub_f32 v76, v76, v22
    v_sub_f32 v77, v77, v22
    v_exp_f32 v26, v76
    v_exp_f32 v27, v77
    s_nop 0
    v_add_f32 v43, v43, v26
    v_add_f32 v43, v43, v27
    v_cvt_pk_bf16_f32 v118, v26, v27
    v_sub_f32 v78, v78, v22
    v_sub_f32 v79, v79, v22
    v_exp_f32 v26, v78
    v_exp_f32 v27, v79
    s_nop 0
    v_add_f32 v43, v43, v26
    v_add_f32 v43, v43, v27
    v_cvt_pk_bf16_f32 v119, v26, v27
    s_nop 7
    s_branch L_back_sA
L_slow_sB:
    s_nop 15
    v_max3_f32 v22, v80, v81, v82
    v_max3_f32 v22, v22, v83, v84
    v_max3_f32 v22, v22, v85, v86
    v_max_f32 v22, v22, v87
    v_mov_b32 v24, v22
    s_nop 1
    v_permlane32_swap_b32 v22, v24
    s_nop 1
    v_max_f32 v22, v22, v24
    v_mov_b32 v24, v22
    s_nop 1
    v_permlane16_swap_b32 v22, v24
    s_nop 1
    v_max_f32 v22, v22, v24
    v_max_f32 v22, 0, v22
    v_exp_f32 v23, -v22
    s_nop 0
    v_mul_f32 v54, v54, v23
    v_mul_f32 v192, v192, v23
    v_mul_f32 v193, v193, v23
    v_mul_f32 v194, v194, v23
    v_mul_f32 v195, v195, v23
    v_mul_f32 v196, v196, v23
    v_mul_f32 v197, v197, v23
    v_mul_f32 v198, v198, v23
    v_mul_f32 v199, v199, v23
    v_mul_f32 v200, v200, v23
    v_mul_f32 v201, v201, v23
    v_mul_f32 v202, v202, v23
    v_mul_f32 v203, v203, v23
    v_mul_f32 v204, v204, v23
    v_mul_f32 v205, v205, v23
    v_mul_f32 v206, v206, v23
    v_mul_f32 v207, v207, v23
    v_mul_f32 v208, v208, v23
    v_mul_f32 v209, v209, v23
    v_mul_f32 v210, v210, v23
    v_mul_f32 v211, v211, v23
    v_mul_f32 v212, v212, v23
    v_mul_f32 v213, v213, v23
    v_mul_f32 v214, v214, v23
    v_mul_f32 v215, v215, v23
    v_mul_f32 v216, v216, v23
    v_mul_f32 v217, v217, v23
    v_mul_f32 v218, v218, v23
    v_mul_f32 v219, v219, v23
    v_mul_f32 v220, v220, v23
    v_mul_f32 v221, v221, v23
    v_mul_f32 v222, v222, v23
    v_mul_f32 v223, v223, v23
    v_sub_f32 v104, v104, v22
    v_sub_f32 v105, v105, v22
    v_sub_f32 v106, v106, v22
    v_sub_f32 v107, v107, v22
    v_sub_f32 v80, v80, v22
    v_sub_f32 v81, v81, v22
    v_exp_f32 v26, v80
    v_exp_f32 v27, v81
    s_nop 0
    v_add_f32 v44, v26, v27
    v_cvt_pk_bf16_f32 v120, v26, v27
    v_sub_f32 v82, v82, v22
    v_sub_f32 v83, v83, v22
    v_exp_f32 v26, v82
    v_exp_f32 v27, v83
    s_nop 0
    v_add_f32 v44, v44, v26
    v_add_f32 v44, v44, v27
    v_cvt_pk_bf16_f32 v121, v26, v27
    v_sub_f32 v84, v84, v22
    v_sub_f32 v85, v85, v22
    v_exp_f32 v26, v84
    v_exp_f32 v27, v85
    s_nop 0
    v_add_f32 v44, v44, v26
    v_add_f32 v44, v44, v27
    v_cvt_pk_bf16_f32 v122, v26, v27
    v_sub_f32 v86, v86, v22
    v_sub_f32 v87, v87, v22
    v_exp_f32 v26, v86
    v_exp_f32 v27, v87
    s_nop 0
    v_add_f32 v44, v44, v26
    v_add_f32 v44, v44, v27
    v_cvt_pk_bf16_f32 v123, v26, v27
    v_max3_f32 v22, v88, v89, v90
    v_max3_f32 v22, v22, v91, v92
    v_max3_f32 v22, v22, v93, v94
    v_max_f32 v22, v22, v95
    v_mov_b32 v24, v22
    s_nop 1
    v_permlane32_swap_b32 v22, v24
    s_nop 1
    v_max_f32 v22, v22, v24
    v_mov_b32 v24, v22
    s_nop 1
    v_permlane16_swap_b32 v22, v24
    s_nop 1
    v_max_f32 v22, v22, v24
    v_max_f32 v22, 0, v22
    v_exp_f32 v23, -v22
    s_nop 0
    v_mul_f32 v55, v55, v23
    v_mul_f32 v224, v224, v23
    v_mul_f32 v225, v225, v23
    v_mul_f32 v226, v226, v23
    v_mul_f32 v227, v227, v23
    v_mul_f32 v228, v228, v23
    v_mul_f32 v229, v229, v23
    v_mul_f32 v230, v230, v23
    v_mul_f32 v231, v231, v23
    v_mul_f32 v232, v232, v23
    v_mul_f32 v233, v233, v23
    v_mul_f32 v234, v234, v23
    v_mul_f32 v235, v235, v23
    v_mul_f32 v236, v236, v23
    v_mul_f32 v237, v237, v23
    v_mul_f32 v238, v238, v23
    v_mul_f32 v239, v239, v23
    v_mul_f32 v240, v240, v23
    v_mul_f32 v241, v241, v23
    v_mul_f32 v242, v242, v23
    v_mul_f32 v243, v243, v23
    v_mul_f32 v244, v244, v23
    v_mul_f32 v245, v245, v23
    v_mul_f32 v246, v246, v23
    v_mul_f32 v247, v247, v23
    v_mul_f32 v248, v248, v23
    v_mul_f32 v249, v249, v23
    v_mul_f32 v250, v250, v23
    v_mul_f32 v251, v251, v23
    v_mul_f32 v252, v252, v23
    v_mul_f32 v253, v253, v23
    v_mul_f32 v254, v254, v23
    v_mul_f32 v255, v255, v23
    v_sub_f32 v108, v108, v22
    v_sub_f32 v109, v109, v22
    v_sub_f32 v110, v110, v22
    v_sub_f32 v111, v111, v22
    v_sub_f32 v88, v88, v22
    v_sub_f32 v89, v89, v22
    v_exp_f32 v26, v88
    v_exp_f32 v27, v89
    s_nop 0
    v_add_f32 v45, v26, v27
    v_cvt_pk_bf16_f32 v124, v26, v27
    v_sub_f32 v90, v90, v22
    v_sub_f32 v91, v91, v22
    v_exp_f32 v26, v90
    v_exp_f32 v27, v91
    s_nop 0
    v_add_f32 v45, v45, v26
    v_add_f32 v45, v45, v27
    v_cvt_pk_bf16_f32 v125, v26, v27
    v_sub_f32 v92, v92, v22
    v_sub_f32 v93, v93, v22
    v_exp_f32 v26, v92
    v_exp_f32 v27, v93
    s_nop 0
    v_add_f32 v45, v45, v26
    v_add_f32 v45, v45, v27
    v_cvt_pk_bf16_f32 v126, v26, v27
    v_sub_f32 v94, v94, v22
    v_sub_f32 v95, v95, v22
    v_exp_f32 v26, v94
    v_exp_f32 v27, v95
    s_nop 0
    v_add_f32 v45, v45, v26
    v_add_f32 v45, v45, v27
    v_cvt_pk_bf16_f32 v127, v26, v27
    s_nop 7
    s_branch L_back_sB
L_slow_sfA:
    s_nop 15
    v_max3_f32 v22, v64, v65, v66
    v_max3_f32 v22, v22, v67, v68
    v_max3_f32 v22, v22, v69, v70
    v_max_f32 v22, v22, v71
    v_mov_b32 v24, v22
    s_nop 1
    v_permlane32_swap_b32 v22, v24
    s_nop 1
    v_max_f32 v22, v22, v24
    v_mov_b32 v24, v22
    s_nop 1
    v_permlane16_swap_b32 v22, v24
    s_nop 1
    v_max_f32 v22, v22, v24
    v_max_f32 v22, 0, v22
    v_exp_f32 v23, -v22
    s_nop 0
    v_mul_f32 v52, v52, v23
    v_mul_f32 v128, v128, v23
    v_mul_f32 v129, v129, v23
    v_mul_f32 v130, v130, v23
    v_mul_f32 v131, v131, v23
    v_mul_f32 v132, v132, v23
    v_mul_f32 v133, v133, v23
    v_mul_f32 v134, v134, v23
    v_mul_f32 v135, v135, v23
    v_mul_f32 v136, v136, v23
    v_mul_f32 v137, v137, v23
    v_mul_f32 v138, v138, v23
    v_mul_f32 v139, v139, v23
    v_mul_f32 v140, v140, v23
    v_mul_f32 v141, v141, v23
    v_mul_f32 v142, v142, v23
    v_mul_f32 v143, v143, v23
    v_mul_f32 v144, v144, v23
    v_mul_f32 v145, v145, v23
    v_mul_f32 v146, v146, v23
    v_mul_f32 v147, v147, v23
    v_mul_f32 v148, v148, v23
    v_mul_f32 v149, v149, v23
    v_mul_f32 v150, v150, v23
    v_mul_f32 v151, v151, v23
    v_mul_f32 v152, v152, v23
    v_mul_f32 v153, v153, v23
    v_mul_f32 v154, v154, v23
    v_mul_f32 v155, v155, v23
    v_mul_f32 v156, v156, v23
    v_mul_f32 v157, v157, v23
    v_mul_f32 v158, v158, v23
    v_mul_f32 v159, v159, v23
    v_sub_f32 v96, v96, v22
    v_sub_f32 v97, v97, v22
    v_sub_f32 v98, v98, v22
    v_sub_f32 v99, v99, v22
    v_sub_f32 v64, v64, v22
    v_sub_f32 v65, v65, v22
    v_exp_f32 v26, v64
    v_exp_f32 v27, v65
    s_nop 0
    v_add_f32 v42, v26, v27
    v_cvt_pk_bf16_f32 v112, v26, v27
    v_sub_f32 v66, v66, v22
    v_sub_f32 v67, v67, v22
    v_exp_f32 v26, v66
    v_exp_f32 v27, v67
    s_nop 0
    v_add_f32 v42, v42, v26
    v_add_f32 v42, v42, v27
    v_cvt_pk_bf16_f32 v113, v26, v27
    v_sub_f32 v68, v68, v22
    v_sub_f32 v69, v69, v22
    v_exp_f32 v26, v68
    v_exp_f32 v27, v69
    s_nop 0
    v_add_f32 v42, v42, v26
    v_add_f32 v42, v42, v27
    v_cvt_pk_bf16_f32 v114, v26, v27
    v_sub_f32 v70, v70, v22
    v_sub_f32 v71, v71, v22
    v_exp_f32 v26, v70
    v_exp_f32 v27, v71
    s_nop 0
    v_add_f32 v42, v42, v26
    v_add_f32 v42, v42, v27
    v_cvt_pk_bf16_f32 v115, v26, v27
    v_max3_f32 v22, v72, v73, v74
    v_max3_f32 v22, v22, v75, v76
    v_max3_f32 v22, v22, v77, v78
    v_max_f32 v22, v22, v79
    v_mov_b32 v24, v22
    s_nop 1
    v_permlane32_swap_b32 v22, v24
    s_nop 1
    v_max_f32 v22, v22, v24
    v_mov_b32 v24, v22
    s_nop 1
    v_permlane16_swap_b32 v22, v24
    s_nop 1
    v_max_f32 v22, v22, v24
    v_max_f32 v22, 0, v22
    v_exp_f32 v23, -v22
    s_nop 0
    v_mul_f32 v53, v53, v23
    v_mul_f32 v160, v160, v23
    v_mul_f32 v161, v161, v23
    v_mul_f32 v162, v162, v23
    v_mul_f32 v163, v163, v23
    v_mul_f32 v164, v164, v23
    v_mul_f32 v165, v165, v23
    v_mul_f32 v166, v166, v23
    v_mul_f32 v167, v167, v23
    v_mul_f32 v168, v168, v23
    v_mul_f32 v169, v169, v23
    v_mul_f32 v170, v170, v23
    v_mul_f32 v171, v171, v23
    v_mul_f32 v172, v172, v23
    v_mul_f32 v173, v173, v23
    v_mul_f32 v174, v174, v23
    v_mul_f32 v175, v175, v23
    v_mul_f32 v176, v176, v23
    v_mul_f32 v177, v177, v23
    v_mul_f32 v178, v178, v23
    v_mul_f32 v179, v179, v23
    v_mul_f32 v180, v180, v23
    v_mul_f32 v181, v181, v23
    v_mul_f32 v182, v182, v23
    v_mul_f32 v183, v183, v23
    v_mul_f32 v184, v184, v23
    v_mul_f32 v185, v185, v23
    v_mul_f32 v186, v186, v23
    v_mul_f32 v187, v187, v23
    v_mul_f32 v188, v188, v23
    v_mul_f32 v189, v189, v23
    v_mul_f32 v190, v190, v23
    v_mul_f32 v191, v191, v23
    v_sub_f32 v100, v100, v22
    v_sub_f32 v101, v101, v22
    v_sub_f32 v102, v102, v22
    v_sub_f32 v103, v103, v22
    v_sub_f32 v72, v72, v22
    v_sub_f32 v73, v73, v22
    v_exp_f32 v26, v72
    v_exp_f32 v27, v73
    s_nop 0
    v_add_f32 v43, v26, v27
    v_cvt_pk_bf16_f32 v116, v26, v27
    v_sub_f32 v74, v74, v22
    v_sub_f32 v75, v75, v22
    v_exp_f32 v26, v74
    v_exp_f32 v27, v75
    s_nop 0
    v_add_f32 v43, v43, v26
    v_add_f32 v43, v43, v27
    v_cvt_pk_bf16_f32 v117, v26, v27
    v_sub_f32 v76, v76, v22
    v_sub_f32 v77, v77, v22
    v_exp_f32 v26, v76
    v_exp_f32 v27, v77
    s_nop 0
    v_add_f32 v43, v43, v26
    v_add_f32 v43, v43, v27
    v_cvt_pk_bf16_f32 v118, v26, v27
    v_sub_f32 v78, v78, v22
    v_sub_f32 v79, v79, v22
    v_exp_f32 v26, v78
    v_exp_f32 v27, v79
    s_nop 0
    v_add_f32 v43, v43, v26
    v_add_f32 v43, v43, v27
    v_cvt_pk_bf16_f32 v119, v26, v27
    s_nop 7
    s_branch L_back_sfA
L_slow_sfB:
    s_nop 15
    v_max3_f32 v22, v80, v81, v82
    v_max3_f32 v22, v22, v83, v84
    v_max3_f32 v22, v22, v85, v86
    v_max_f32 v22, v22, v87
    v_mov_b32 v24, v22
    s_nop 1
    v_permlane32_swap_b32 v22, v24
    s_nop 1
    v_max_f32 v22, v22, v24
    v_mov_b32 v24, v22
    s_nop 1
    v_permlane16_swap_b32 v22, v24
    s_nop 1
    v_max_f32 v22, v22, v24
    v_max_f32 v22, 0, v22
    v_exp_f32 v23, -v22
    s_nop 0
    v_mul_f32 v54, v54, v23
    v_mul_f32 v192, v192, v23
    v_mul_f32 v193, v193, v23
    v_mul_f32 v194, v194, v23
    v_mul_f32 v195, v195, v23
    v_mul_f32 v196, v196, v23
    v_mul_f32 v197, v197, v23
    v_mul_f32 v198, v198, v23
    v_mul_f32 v199, v199, v23
    v_mul_f32 v200, v200, v23
    v_mul_f32 v201, v201, v23
    v_mul_f32 v202, v202, v23
    v_mul_f32 v203, v203, v23
    v_mul_f32 v204, v204, v23
    v_mul_f32 v205, v205, v23
    v_mul_f32 v206, v206, v23
    v_mul_f32 v207, v207, v23
    v_mul_f32 v208, v208, v23
    v_mul_f32 v209, v209, v23
    v_mul_f32 v210, v210, v23
    v_mul_f32 v211, v211, v23
    v_mul_f32 v212, v212, v23
    v_mul_f32 v213, v213, v23
    v_mul_f32 v214, v214, v23
    v_mul_f32 v215, v215, v23
    v_mul_f32 v216, v216, v23
    v_mul_f32 v217, v217, v23
    v_mul_f32 v218, v218, v23
    v_mul_f32 v219, v219, v23
    v_mul_f32 v220, v220, v23
    v_mul_f32 v221, v221, v23
    v_mul_f32 v222, v222, v23
    v_mul_f32 v223, v223, v23
    v_sub_f32 v104, v104, v22
    v_sub_f32 v105, v105, v22
    v_sub_f32 v106, v106, v22
    v_sub_f32 v107, v107, v22
    v_sub_f32 v80, v80, v22
    v_sub_f32 v81, v81, v22
    v_exp_f32 v26, v80
    v_exp_f32 v27, v81
    s_nop 0
    v_add_f32 v44, v26, v27
    v_cvt_pk_bf16_f32 v120, v26, v27
    v_sub_f32 v82, v82, v22
    v_sub_f32 v83, v83, v22
    v_exp_f32 v26, v82
    v_exp_f32 v27, v83
    s_nop 0
    v_add_f32 v44, v44, v26
    v_add_f32 v44, v44, v27
    v_cvt_pk_bf16_f32 v121, v26, v27
    v_sub_f32 v84, v84, v22
    v_sub_f32 v85, v85, v22
    v_exp_f32 v26, v84
    v_exp_f32 v27, v85
    s_nop 0
    v_add_f32 v44, v44, v26
    v_add_f32 v44, v44, v27
    v_cvt_pk_bf16_f32 v122, v26, v27
    v_sub_f32 v86, v86, v22
    v_sub_f32 v87, v87, v22
    v_exp_f32 v26, v86
    v_exp_f32 v27, v87
    s_nop 0
    v_add_f32 v44, v44, v26
    v_add_f32 v44, v44, v27
    v_cvt_pk_bf16_f32 v123, v26, v27
    v_max3_f32 v22, v88, v89, v90
    v_max3_f32 v22, v22, v91, v92
    v_max3_f32 v22, v22, v93, v94
    v_max_f32 v22, v22, v95
    v_mov_b32 v24, v22
    s_nop 1
    v_permlane32_swap_b32 v22, v24
    s_nop 1
    v_max_f32 v22, v22, v24
    v_mov_b32 v24, v22
    s_nop 1
    v_permlane16_swap_b32 v22, v24
    s_nop 1
    v_max_f32 v22, v22, v24
    v_max_f32 v22, 0, v22
    v_exp_f32 v23, -v22
    s_nop 0
    v_mul_f32 v55, v55, v23
    v_mul_f32 v224, v224, v23
    v_mul_f32 v225, v225, v23
    v_mul_f32 v226, v226, v23
    v_mul_f32 v227, v227, v23
    v_mul_f32 v228, v228, v23
    v_mul_f32 v229, v229, v23
    v_mul_f32 v230, v230, v23
    v_mul_f32 v231, v231, v23
    v_mul_f32 v232, v232, v23
    v_mul_f32 v233, v233, v23
    v_mul_f32 v234, v234, v23
    v_mul_f32 v235, v235, v23
    v_mul_f32 v236, v236, v23
    v_mul_f32 v237, v237, v23
    v_mul_f32 v238, v238, v23
    v_mul_f32 v239, v239, v23
    v_mul_f32 v240, v240, v23
    v_mul_f32 v241, v241, v23
    v_mul_f32 v242, v242, v23
    v_mul_f32 v243, v243, v23
    v_mul_f32 v244, v244, v23
    v_mul_f32 v245, v245, v23
    v_mul_f32 v246, v246, v23
    v_mul_f32 v247, v247, v23
    v_mul_f32 v248, v248, v23
    v_mul_f32 v249, v249, v23
    v_mul_f32 v250, v250, v23
    v_mul_f32 v251, v251, v23
    v_mul_f32 v252, v252, v23
    v_mul_f32 v253, v253, v23
    v_mul_f32 v254, v254, v23
    v_mul_f32 v255, v255, v23
    v_sub_f32 v108, v108, v22
    v_sub_f32 v109, v109, v22
    v_sub_f32 v110, v110, v22
    v_sub_f32 v111, v111, v22
    v_sub_f32 v88, v88, v22
    v_sub_f32 v89, v89, v22
    v_exp_f32 v26, v88
    v_exp_f32 v27, v89
    s_nop 0
    v_add_f32 v45, v26, v27
    v_cvt_pk_bf16_f32 v124, v26, v27
    v_sub_f32 v90, v90, v22
    v_sub_f32 v91, v91, v22
    v_exp_f32 v26, v90
    v_exp_f32 v27, v91
    s_nop 0
    v_add_f32 v45, v45, v26
    v_add_f32 v45, v45, v27
    v_cvt_pk_bf16_f32 v125, v26, v27
    v_sub_f32 v92, v92, v22
    v_sub_f32 v93, v93, v22
    v_exp_f32 v26, v92
    v_exp_f32 v27, v93
    s_nop 0
    v_add_f32 v45, v45, v26
    v_add_f32 v45, v45, v27
    v_cvt_pk_bf16_f32 v126, v26, v27
    v_sub_f32 v94, v94, v22
    v_sub_f32 v95, v95, v22
    v_exp_f32 v26, v94
    v_exp_f32 v27, v95
    s_nop 0
    v_add_f32 v45, v45, v26
    v_add_f32 v45, v45, v27
    v_cvt_pk_bf16_f32 v127, v26, v27
    s_nop 7
    s_branch L_back_sfB
L_k2_last:

.section .rodata,"a"
.p2align 6
.amdhsa_kernel k1_proj_kernel
  .amdhsa_next_free_vgpr 240
  .amdhsa_next_free_sgpr 64
  .amdhsa_accum_offset 240
  .amdhsa_group_segment_fixed_size 0
  .amdhsa_kernarg_size 96
  .amdhsa_user_sgpr_count 2
  .amdhsa_user_sgpr_kernarg_segment_ptr 1
  .amdhsa_system_sgpr_workgroup_id_x 1
.end_amdhsa_kernel
.p2align 6
.amdhsa_kernel k2_attn_kernel
  .amdhsa_next_free_vgpr 512
  .amdhsa_next_free_sgpr 102
  .amdhsa_accum_offset 256
  .amdhsa_group_segment_fixed_size 0
  .amdhsa_kernarg_size 96
  .amdhsa_user_sgpr_count 2
  .amdhsa_user_sgpr_kernarg_segment_ptr 1
  .amdhsa_system_sgpr_workgroup_id_x 1
.end_amdhsa_kernel
```
